```python
import torch

def _softmax(x, axis=-1):
    return torch.softmax(x, dim=axis)
def _gelu(x):
    return torch.nn.functional.gelu(x, approximate="tanh")
def _silu(x):
    return torch.nn.functional.silu(x)
def _sigmoid(x):
    return torch.sigmoid(x)
def _layernorm(x, axis=-1, eps=1e-5):
    m = x.mean(dim=axis, keepdim=True)
    v = x.var(dim=axis, keepdim=True, unbiased=False)
    return (x - m) / torch.sqrt(v + eps)
def _scatter_add(tgt, idx, src, axis=0):
    return tgt.clone().index_add_(axis, idx, src)
def _segment_sum(src, seg, n):
    out = torch.zeros((n,) + src.shape[1:], dtype=src.dtype)
    return out.index_add_(0, seg, src)
def _pad(x, pw):
    flat = tuple(v for pair in reversed(pw) for v in pair)
    return torch.nn.functional.pad(x, flat)

kernel_name = 'concat_heads__mha_block_cached__gqa_block_cached__near_ridge'

def setup_inputs():

    _w = (lambda a: (lambda t: t.to(torch.bfloat16) if t.is_floating_point() else t)(torch.as_tensor(a)))
    def _A_setup():
        B, Sq, D = 16, 48, 1024
        H, Sk, Dh = 32, 48, 128
        return {
            "x": _w((lambda *s: torch.randn(*s, dtype=torch.bfloat16) * 0.8)(B, Sq, D)),
            "k_cache": _w((lambda *s: torch.randn(*s, dtype=torch.bfloat16) * 0.8)(B, H, Sk, Dh)),
            "v_cache": _w((lambda *s: torch.randn(*s, dtype=torch.bfloat16) * 0.05)(B, H, Sk, Dh)),
            "wq": _w((lambda *s: torch.randn(*s, dtype=torch.bfloat16) * 0.8)(D, H * Dh) * (D ** -0.5)),
            "wo": _w((lambda *s: torch.randn(*s, dtype=torch.bfloat16) * 0.05)(H * Dh, D) * ((H * Dh) ** -0.5)),
        }
    _A_in = _A_setup()

    def _B_setup():
        B, Sq, D = 16, 48, 1024
        Hq, Hkv, Sk, Dh = 32, 32, 48, 128
        assert Hq % Hkv == 0, (Hq, Hkv)
        return {
            "x": _w((lambda *s: torch.randn(*s, dtype=torch.bfloat16) * 0.8)(B, Sq, D)),
            "k_cache": _w((lambda *s: torch.randn(*s, dtype=torch.bfloat16) * 0.8)(B, Hkv, Sk, Dh)),
            "v_cache": _w((lambda *s: torch.randn(*s, dtype=torch.bfloat16) * 0.05)(B, Hkv, Sk, Dh)),
            "wq": _w((lambda *s: torch.randn(*s, dtype=torch.bfloat16) * 0.8)(D, Hq * Dh) * (D ** -0.5)),
            "wo": _w((lambda *s: torch.randn(*s, dtype=torch.bfloat16) * 0.05)(Hq * Dh, D) * ((Hq * Dh) ** -0.5)),
        }
    _B_in = _B_setup()

    return {
        "A_x": _A_in["x"],
        "A_k_cache": _A_in["k_cache"],
        "A_v_cache": _A_in["v_cache"],
        "A_wq": _A_in["wq"],
        "A_wo": _A_in["wo"],
        "B_x": _B_in["x"],
        "B_k_cache": _B_in["k_cache"],
        "B_v_cache": _B_in["v_cache"],
        "B_wq": _B_in["wq"],
        "B_wo": _B_in["wo"],
    }

def reference(A_x, A_k_cache, A_v_cache, A_wq, A_wo, B_x, B_k_cache, B_v_cache, B_wq, B_wo):
    def _A_ref(x, k_cache, v_cache, wq, wo):
        B, Sq, D = x.shape
        H, Dh = 32, 128
        q = (lambda x, *d: x.permute(*d))((x @ wq).reshape(B, Sq, H, Dh), 0, 2, 1, 3)
        scores = torch.einsum("bhqd,bhkd->bhqk", q, k_cache) * (Dh ** -0.5)
        p = _softmax(scores, axis=-1)
        o = torch.einsum("bhqk,bhkd->bhqd", p, v_cache)
        return (lambda x, *d: x.permute(*d))(o, 0, 2, 1, 3).reshape(B, Sq, H * Dh) @ wo

    def _B_ref(x, k_cache, v_cache, wq, wo):
        B, Sq, D = x.shape
        Hq, Dh = 32, 128
        Hkv = k_cache.shape[1]
        rep = Hq // Hkv
        q = (lambda x, *d: x.permute(*d))((x @ wq).reshape(B, Sq, Hq, Dh), 0, 2, 1, 3)
        k = (lambda x, n, axis: torch.repeat_interleave(x, n, dim=axis))(k_cache, rep, axis=1)
        v = (lambda x, n, axis: torch.repeat_interleave(x, n, dim=axis))(v_cache, rep, axis=1)
        scores = torch.einsum("bhqd,bhkd->bhqk", q, k) * (Dh ** -0.5)
        p = _softmax(scores, axis=-1)
        o = torch.einsum("bhqk,bhkd->bhqd", p, v)
        return (lambda x, *d: x.permute(*d))(o, 0, 2, 1, 3).reshape(B, Sq, Hq * Dh) @ wo

    a = _A_ref(A_x, A_k_cache, A_v_cache, A_wq, A_wo)
    b = _B_ref(B_x, B_k_cache, B_v_cache, B_wq, B_wo)
    return torch.concatenate([a, b], axis=-1)
```

```asm
; @launch grid=(256,1,1) block=(256,1,1) lds=163840
.amdgcn_target "amdgcn-amd-amdhsa--gfx950"
.text
.globl concat_heads__mha_block_cached__gqa_block_cached__near_ridge_kernel
.p2align 8
.type concat_heads__mha_block_cached__gqa_block_cached__near_ridge_kernel,@function
concat_heads__mha_block_cached__gqa_block_cached__near_ridge_kernel:
L_start_ached__near_ridge_kernel:
  s_cmp_ge_u32 s2, 0x100
  s_cbranch_scc1 L_exit_ached__near_ridge_kernel
  v_lshrrev_b32 v1, 6, v0
  s_and_b32 s4, s2, 7
  v_readfirstlane_b32 s3, v1
  s_lshr_b32 s26, s4, 2
  s_and_b32 s30, s4, 3
  s_lshr_b32 s31, s2, 3
  s_mul_i32 s5, s26, 40
  s_add_u32 s6, s0, s5
  s_addc_u32 s7, s1, 0
  s_load_dwordx8 s[8:15], s[6:7], 0
  s_load_dwordx2 s[16:17], s[6:7], 32
  s_load_dwordx4 s[20:23], s[0:1], 80
  s_load_dwordx2 s[24:25], s[0:1], 96
  v_and_b32 v0, 63, v0
  s_getpc_b64 s[18:19]
L_pc2_ached__near_ridge_kernel:
  s_sub_u32 s18, s18, L_pc2_ached__near_ridge_kernel-L_start_ached__near_ridge_kernel
  s_subb_u32 s19, s19, 0
  s_lshl_b32 s4, s31, 2
  s_add_u32 s4, s4, s3
  s_mul_i32 s4, s4, 384
  v_lshl_add_u32 v7, v0, 7, s4
  v_min_u32 v7, L_exit_ached__near_ridge_kernel-L_start_ached__near_ridge_kernel, v7
  s_mov_b64 exec, 7
  global_load_dword v254, v7, s[18:19]
  s_mov_b64 exec, -1
  s_and_b32 s29, s31, 3
  s_lshr_b32 s4, s31, 2
  s_lshl_b32 s27, s4, 2
  s_add_u32 s27, s27, s30
  s_lshl_b32 s28, s29, 2
  s_add_u32 s28, s28, s3
  s_mul_i32 s64, s28, 98304
  s_lshl_b32 s4, s3, 17
  s_lshl_b32 s65, s27, 8
  s_add_u32 s65, s65, s4
  s_mul_i32 s68, s3, 6144
  s_add_u32 s68, s68, 49152
  s_lshl_b32 s69, s3, 12
  s_mul_i32 s4, s29, 1
  s_lshr_b32 s5, s31, 2
  s_mul_i32 s5, s5, 3
  s_add_u32 s4, s4, s5
  s_and_b32 s4, s4, 3
  s_mov_b32 s77, 1967534338
  s_mov_b32 s75, 4258183562
  s_cmp_eq_u32 s4, 1
  s_cselect_b32 s77, 1702109488, s77
  s_cselect_b32 s75, 3992758712, s75
  s_cmp_eq_u32 s4, 2
  s_cselect_b32 s77, 1750279184, s77
  s_cselect_b32 s75, 4275809431, s75
  s_cmp_eq_u32 s4, 3
  s_cselect_b32 s77, 2520994320, s77
  s_cselect_b32 s75, 4274772615, s75
  s_mov_b32 s78, s64
  s_mov_b32 s79, s65
  s_and_b32 s4, s77, 15
  s_lshl_b32 s5, s4, 7
  s_add_u32 s64, s78, s5
  s_lshl_b32 s4, s4, 19
  s_add_u32 s65, s79, s4
  v_lshrrev_b32 v1, 3, v0
  v_lshrrev_b32 v2, 4, v0
  v_and_b32 v3, 15, v0
  v_lshrrev_b32 v4, 1, v3
  v_and_b32 v5, 1, v0
  v_or_b32 v6, 0, v2
  v_xor_b32 v6, v6, v4
  v_lshlrev_b32 v6, 5, v6
  v_lshl_add_u32 v6, v5, 4, v6
  v_lshl_add_u32 v6, v2, 13, v6
  v_add_u32 v110, 0, v6
  v_add_u32 v111, 31744, v6
  v_or_b32 v6, 4, v2
  v_xor_b32 v6, v6, v4
  v_lshlrev_b32 v6, 5, v6
  v_lshl_add_u32 v6, v5, 4, v6
  v_lshl_add_u32 v6, v2, 13, v6
  v_add_u32 v112, 63488, v6
  v_add_u32 v113, 95232, v6
  v_and_b32 v4, 7, v0
  v_or_b32 v6, 0, v2
  v_xor_b32 v6, v6, v4
  v_lshlrev_b32 v6, 4, v6
  v_lshl_add_u32 v6, v1, 11, v6
  v_add_u32 v104, 0, v6
  v_add_u32 v106, 30720, v6
  v_add_u32 v108, 65536, v6
  v_or_b32 v6, 4, v2
  v_xor_b32 v6, v6, v4
  v_lshlrev_b32 v6, 4, v6
  v_lshl_add_u32 v6, v1, 11, v6
  v_add_u32 v105, 15360, v6
  v_add_u32 v107, 46080, v6
  v_add_u32 v109, 80896, v6
  s_waitcnt lgkmcnt(0)
  s_mov_b32 s36, s14
  s_and_b32 s37, s15, 0xffff
  s_mov_b32 s38, 8388608
  s_mov_b32 s39, 0x20000
  s_mov_b32 s32, s8
  s_and_b32 s33, s9, 0xffff
  s_mov_b32 s34, 1572864
  s_mov_b32 s35, 0x20000
  s_add_u32 m0, s69, 0
  s_nop 0
  buffer_load_dwordx4 v110, s[36:39], s65 offen offset:0  lds
  buffer_load_dwordx4 v111, s[36:39], s65 offen offset:1024  lds
  buffer_load_dwordx4 v112, s[36:39], s65 offen offset:2048  lds
  buffer_load_dwordx4 v113, s[36:39], s65 offen offset:3072  lds
  s_add_u32 m0, s68, 0
  s_nop 0
  buffer_load_dwordx4 v104, s[32:35], s64 offen offset:0  lds
  buffer_load_dwordx4 v105, s[32:35], s64 offen offset:1024  lds
  buffer_load_dwordx4 v106, s[32:35], s64 offen offset:2048  lds
  buffer_load_dwordx4 v107, s[32:35], s64 offen offset:3072  lds
  s_add_u32 m0, s68, 4096
  s_nop 0
  buffer_load_dwordx4 v108, s[32:35], s64 offen offset:0  lds
  buffer_load_dwordx4 v109, s[32:35], s64 offen offset:1024  lds
  s_bfe_u32 s4, s77, 0x40004
  s_lshl_b32 s5, s4, 7
  s_add_u32 s64, s78, s5
  s_lshl_b32 s4, s4, 19
  s_add_u32 s65, s79, s4
  s_mov_b32 s40, s10
  s_and_b32 s41, s11, 0xffff
  s_mov_b32 s42, 6291456
  s_mov_b32 s43, 0x20000
  s_mov_b32 s44, s12
  s_and_b32 s45, s13, 0xffff
  s_mov_b32 s46, 6291456
  s_mov_b32 s47, 0x20000
  s_mov_b32 s52, s16
  s_and_b32 s53, s17, 0xffff
  s_mov_b32 s54, 8388608
  s_mov_b32 s55, 0x20000
  s_mov_b32 s56, s20
  s_and_b32 s57, s21, 0xffff
  s_mov_b32 s58, 3145728
  s_mov_b32 s59, 0x20000
  s_mov_b32 s60, s22
  s_and_b32 s61, s23, 0xffff
  s_mov_b32 s62, 256
  s_mov_b32 s63, 0x20000
  s_mov_b32 s48, s24
  s_and_b32 s49, s25, 0xffff
  s_mov_b32 s50, 268435456
  s_mov_b32 s51, 0x20000
  s_lshl_b32 s4, s28, 5
  s_add_u32 s4, s4, s27
  s_mul_i32 s66, s4, 12288
  s_lshl_b32 s4, s26, 3
  s_lshr_b32 s5, s28, 1
  s_add_u32 s4, s4, s5
  s_mul_i32 s4, s4, 786432
  s_mul_i32 s67, s27, 24576
  s_add_u32 s67, s67, s4
  s_and_b32 s5, s28, 1
  s_mul_i32 s5, s5, 3072
  s_add_u32 s67, s67, s5
  s_mov_b32 s74, 122880
  s_cmp_eq_u32 s3, 1
  s_cselect_b32 s74, 127488, s74
  s_cmp_eq_u32 s3, 2
  s_cselect_b32 s74, 132096, s74
  s_cmp_eq_u32 s3, 3
  s_cselect_b32 s74, 136704, s74
  s_mov_b32 s76, 0x3e0293ee
  s_lshl_b32 s4, s26, 4
  s_lshl_b32 s5, s29, 2
  s_add_u32 s4, s4, s5
  s_lshr_b32 s5, s27, 3
  s_add_u32 s4, s4, s5
  s_lshl_b32 s100, s4, 3
  s_mov_b32 s70, s66
  s_add_u32 s71, s66, 4096
  s_add_u32 s72, s66, 8192
  s_and_b32 s18, s31, 7
  s_lshr_b32 s5, s31, 3
  s_lshl_b32 s5, s5, 2
  s_add_u32 s19, s30, s5
  s_mov_b32 s10, 90112
  s_mov_b32 s11, 94208
  s_mov_b32 s16, 114688
  s_cmp_eq_u32 s3, 1
  s_cselect_b32 s10, 118784, s10
  s_cselect_b32 s11, 65536, s11
  s_cselect_b32 s16, 69632, s16
  s_cmp_eq_u32 s3, 2
  s_cselect_b32 s10, 122880, s10
  s_cselect_b32 s11, 126976, s11
  s_cselect_b32 s16, 131072, s16
  s_cmp_eq_u32 s3, 3
  s_cselect_b32 s10, 135168, s10
  s_cselect_b32 s11, 139264, s11
  s_cselect_b32 s16, 159744, s16
  s_lshl_b32 s4, s26, 4
  s_lshr_b32 s5, s18, 1
  s_lshl_b32 s5, s5, 2
  s_add_u32 s4, s4, s5
  s_add_u32 s4, s4, s3
  s_lshl_b32 s101, s4, 3
  v_lshrrev_b32 v4, 2, v3
  v_and_b32 v5, 3, v0
  v_and_b32 v6, 1, v2
  v_lshl_or_b32 v6, v6, 2, v4
  v_lshl_add_u32 v7, v2, 3, v4
  v_lshlrev_b32 v7, 8, v7
  v_lshl_add_u32 v7, v5, 3, v7
  v_lshl_add_u32 v114, v6, 5, v7
  v_xor_b32 v115, 32, v114
  v_xor_b32 v116, 64, v114
  v_xor_b32 v117, 96, v114
  v_xor_b32 v118, 128, v114
  v_xor_b32 v119, 160, v114
  v_xor_b32 v120, 192, v114
  v_xor_b32 v121, 224, v114
  v_lshrrev_b32 v6, 1, v3
  v_xor_b32 v6, v6, v2
  v_lshlrev_b32 v6, 4, v6
  v_lshl_add_u32 v6, v3, 7, v6
  v_add_u32 v122, s68, v6
  v_xor_b32 v123, 64, v122
  v_lshlrev_b32 v124, 4, v0
  v_mul_u32_u24 v6, 272, v2
  v_lshl_add_u32 v6, v3, 4, v6
  v_add_u32 v125, s74, v6
  v_mul_u32_u24 v6, 288, v2
  v_lshl_add_u32 v6, v3, 4, v6
  v_add_u32 v126, s74, v6
  v_mul_u32_u24 v6, 272, v3
  v_lshl_add_u32 v6, v2, 3, v6
  v_add_u32 v127, s74, v6
  v_lshl_add_u32 v6, v2, 2, v4
  v_mul_u32_u24 v7, 288, v6
  v_lshl_add_u32 v7, v5, 3, v7
  v_add_u32 v128, s74, v7
  v_lshrrev_b32 v7, 1, v6
  v_and_b32 v7, 3, v7
  v_lshlrev_b32 v6, 7, v6
  v_lshl_add_u32 v6, v5, 3, v6
  v_lshl_add_u32 v6, v7, 5, v6
  v_mov_b32 v134, v6
  v_xor_b32 v135, 32, v134
  v_xor_b32 v136, 64, v134
  v_xor_b32 v137, 96, v134
  v_and_b32 v6, 7, v0
  v_lshrrev_b32 v6, 1, v6
  v_xor_b32 v6, v6, v2
  v_lshlrev_b32 v6, 5, v6
  v_and_b32 v7, 1, v0
  v_lshl_add_u32 v6, v7, 4, v6
  v_lshl_add_u32 v130, v1, 11, v6
  v_add_u32 v131, 15360, v130
  v_add_u32 v132, 30720, v130
  v_add_u32 v133, 46080, v130
  s_add_u32 m0, s69, 16384
  s_nop 0
  buffer_load_dwordx4 v110, s[36:39], s65 offen offset:0  lds
  buffer_load_dwordx4 v111, s[36:39], s65 offen offset:1024  lds
  buffer_load_dwordx4 v112, s[36:39], s65 offen offset:2048  lds
  buffer_load_dwordx4 v113, s[36:39], s65 offen offset:3072  lds
  s_add_u32 m0, s68, 24576
  s_nop 0
  buffer_load_dwordx4 v104, s[32:35], s64 offen offset:0  lds
  buffer_load_dwordx4 v105, s[32:35], s64 offen offset:1024  lds
  buffer_load_dwordx4 v106, s[32:35], s64 offen offset:2048  lds
  buffer_load_dwordx4 v107, s[32:35], s64 offen offset:3072  lds
  s_add_u32 m0, s68, 28672
  s_nop 0
  buffer_load_dwordx4 v108, s[32:35], s64 offen offset:0  lds
  buffer_load_dwordx4 v109, s[32:35], s64 offen offset:1024  lds
  s_bfe_u32 s4, s77, 0x40008
  s_lshl_b32 s5, s4, 7
  s_add_u32 s64, s78, s5
  s_lshl_b32 s4, s4, 19
  s_add_u32 s65, s79, s4
  s_waitcnt vmcnt(10)
  s_barrier
  ds_read_b128 a[160:163], v122 offset:0
  ds_read_b128 a[164:167], v122 offset:2048
  ds_read_b128 a[168:171], v122 offset:4096
  ds_read_b64_tr_b16 a[96:97], v114 offset:0
  ds_read_b64_tr_b16 a[98:99], v114 offset:1024
  ds_read_b64_tr_b16 a[100:101], v115 offset:0
  ds_read_b64_tr_b16 a[102:103], v115 offset:1024
  ds_read_b64_tr_b16 a[104:105], v116 offset:0
  ds_read_b64_tr_b16 a[106:107], v116 offset:1024
  ds_read_b64_tr_b16 a[108:109], v117 offset:0
  ds_read_b64_tr_b16 a[110:111], v117 offset:1024
  ds_read_b64_tr_b16 a[112:113], v118 offset:0
  ds_read_b64_tr_b16 a[114:115], v118 offset:1024
  ds_read_b64_tr_b16 a[116:117], v119 offset:0
  ds_read_b64_tr_b16 a[118:119], v119 offset:1024
  ds_read_b64_tr_b16 a[120:121], v120 offset:0
  ds_read_b64_tr_b16 a[122:123], v120 offset:1024
  ds_read_b64_tr_b16 a[124:125], v121 offset:0
  ds_read_b64_tr_b16 a[126:127], v121 offset:1024
  s_waitcnt lgkmcnt(0)
  v_mfma_f32_16x16x32_bf16 v[8:11], a[96:99], a[160:163], 0
  ds_read_b128 a[172:175], v123 offset:0
  ds_read_b128 a[176:179], v123 offset:2048
  v_mfma_f32_16x16x32_bf16 v[20:23], a[100:103], a[160:163], 0
  s_add_u32 m0, s69, 32768
  ds_read_b128 a[180:183], v123 offset:4096
  v_mfma_f32_16x16x32_bf16 v[32:35], a[104:107], a[160:163], 0
  buffer_load_dwordx4 v110, s[36:39], s65 offen offset:0  lds
  ds_read_b64_tr_b16 a[128:129], v114 offset:8192
  v_mfma_f32_16x16x32_bf16 v[44:47], a[108:111], a[160:163], 0
  ds_read_b64_tr_b16 a[130:131], v114 offset:9216
  ds_read_b64_tr_b16 a[132:133], v115 offset:8192
  v_mfma_f32_16x16x32_bf16 v[56:59], a[112:115], a[160:163], 0
  buffer_load_dwordx4 v111, s[36:39], s65 offen offset:1024  lds
  ds_read_b64_tr_b16 a[134:135], v115 offset:9216
  v_mfma_f32_16x16x32_bf16 v[68:71], a[116:119], a[160:163], 0
  ds_read_b64_tr_b16 a[136:137], v116 offset:8192
  ds_read_b64_tr_b16 a[138:139], v116 offset:9216
  v_mfma_f32_16x16x32_bf16 v[80:83], a[120:123], a[160:163], 0
  buffer_load_dwordx4 v112, s[36:39], s65 offen offset:2048  lds
  ds_read_b64_tr_b16 a[140:141], v117 offset:8192
  v_mfma_f32_16x16x32_bf16 v[92:95], a[124:127], a[160:163], 0
  ds_read_b64_tr_b16 a[142:143], v117 offset:9216
  ds_read_b64_tr_b16 a[144:145], v118 offset:8192
  v_mfma_f32_16x16x32_bf16 v[12:15], a[96:99], a[164:167], 0
  buffer_load_dwordx4 v113, s[36:39], s65 offen offset:3072  lds
  ds_read_b64_tr_b16 a[146:147], v118 offset:9216
  v_mfma_f32_16x16x32_bf16 v[24:27], a[100:103], a[164:167], 0
  s_add_u32 m0, s68, 49152
  ds_read_b64_tr_b16 a[148:149], v119 offset:8192
  v_mfma_f32_16x16x32_bf16 v[36:39], a[104:107], a[164:167], 0
  buffer_load_dwordx4 v104, s[32:35], s64 offen offset:0  lds
  ds_read_b64_tr_b16 a[150:151], v119 offset:9216
  v_mfma_f32_16x16x32_bf16 v[48:51], a[108:111], a[164:167], 0
  ds_read_b64_tr_b16 a[152:153], v120 offset:8192
  ds_read_b64_tr_b16 a[154:155], v120 offset:9216
  v_mfma_f32_16x16x32_bf16 v[60:63], a[112:115], a[164:167], 0
  buffer_load_dwordx4 v105, s[32:35], s64 offen offset:1024  lds
  ds_read_b64_tr_b16 a[156:157], v121 offset:8192
  v_mfma_f32_16x16x32_bf16 v[72:75], a[116:119], a[164:167], 0
  ds_read_b64_tr_b16 a[158:159], v121 offset:9216
  v_mfma_f32_16x16x32_bf16 v[84:87], a[120:123], a[164:167], 0
  buffer_load_dwordx4 v106, s[32:35], s64 offen offset:2048  lds
  v_mfma_f32_16x16x32_bf16 v[96:99], a[124:127], a[164:167], 0
  v_mfma_f32_16x16x32_bf16 v[16:19], a[96:99], a[168:171], 0
  buffer_load_dwordx4 v107, s[32:35], s64 offen offset:3072  lds
  v_mfma_f32_16x16x32_bf16 v[28:31], a[100:103], a[168:171], 0
  s_add_u32 m0, s68, 53248
  v_mfma_f32_16x16x32_bf16 v[40:43], a[104:107], a[168:171], 0
  buffer_load_dwordx4 v108, s[32:35], s64 offen offset:0  lds
  v_mfma_f32_16x16x32_bf16 v[52:55], a[108:111], a[168:171], 0
  v_mfma_f32_16x16x32_bf16 v[64:67], a[112:115], a[168:171], 0
  buffer_load_dwordx4 v109, s[32:35], s64 offen offset:1024  lds
  s_bfe_u32 s4, s77, 0x4000c
  v_mfma_f32_16x16x32_bf16 v[76:79], a[116:119], a[168:171], 0
  s_lshl_b32 s5, s4, 7
  s_add_u32 s64, s78, s5
  v_mfma_f32_16x16x32_bf16 v[88:91], a[120:123], a[168:171], 0
  s_lshl_b32 s4, s4, 19
  s_add_u32 s65, s79, s4
  v_mfma_f32_16x16x32_bf16 v[100:103], a[124:127], a[168:171], 0
  s_waitcnt vmcnt(10) lgkmcnt(0)
  s_barrier
  v_mfma_f32_16x16x32_bf16 v[8:11], a[128:131], a[172:175], v[8:11]
  ds_read_b128 a[160:163], v122 offset:24576
  ds_read_b128 a[164:167], v122 offset:26624
  v_mfma_f32_16x16x32_bf16 v[20:23], a[132:135], a[172:175], v[20:23]
  s_add_u32 m0, s69, 0
  ds_read_b128 a[168:171], v122 offset:28672
  v_mfma_f32_16x16x32_bf16 v[32:35], a[136:139], a[172:175], v[32:35]
  buffer_load_dwordx4 v110, s[36:39], s65 offen offset:0  lds
  ds_read_b64_tr_b16 a[96:97], v114 offset:16384
  v_mfma_f32_16x16x32_bf16 v[44:47], a[140:143], a[172:175], v[44:47]
  ds_read_b64_tr_b16 a[98:99], v114 offset:17408
  ds_read_b64_tr_b16 a[100:101], v115 offset:16384
  v_mfma_f32_16x16x32_bf16 v[56:59], a[144:147], a[172:175], v[56:59]
  ds_read_b64_tr_b16 a[102:103], v115 offset:17408
  ds_read_b64_tr_b16 a[104:105], v116 offset:16384
  v_mfma_f32_16x16x32_bf16 v[68:71], a[148:151], a[172:175], v[68:71]
  ds_read_b64_tr_b16 a[106:107], v116 offset:17408
  v_mfma_f32_16x16x32_bf16 v[80:83], a[152:155], a[172:175], v[80:83]
  buffer_load_dwordx4 v111, s[36:39], s65 offen offset:1024  lds
  ds_read_b64_tr_b16 a[108:109], v117 offset:16384
  v_mfma_f32_16x16x32_bf16 v[92:95], a[156:159], a[172:175], v[92:95]
  ds_read_b64_tr_b16 a[110:111], v117 offset:17408
  ds_read_b64_tr_b16 a[112:113], v118 offset:16384
  v_mfma_f32_16x16x32_bf16 v[12:15], a[128:131], a[176:179], v[12:15]
  ds_read_b64_tr_b16 a[114:115], v118 offset:17408
  ds_read_b64_tr_b16 a[116:117], v119 offset:16384
  v_mfma_f32_16x16x32_bf16 v[24:27], a[132:135], a[176:179], v[24:27]
  ds_read_b64_tr_b16 a[118:119], v119 offset:17408
  v_mfma_f32_16x16x32_bf16 v[36:39], a[136:139], a[176:179], v[36:39]
  buffer_load_dwordx4 v112, s[36:39], s65 offen offset:2048  lds
  ds_read_b64_tr_b16 a[120:121], v120 offset:16384
  v_mfma_f32_16x16x32_bf16 v[48:51], a[140:143], a[176:179], v[48:51]
  ds_read_b64_tr_b16 a[122:123], v120 offset:17408
  ds_read_b64_tr_b16 a[124:125], v121 offset:16384
  v_mfma_f32_16x16x32_bf16 v[60:63], a[144:147], a[176:179], v[60:63]
  ds_read_b64_tr_b16 a[126:127], v121 offset:17408
  v_mfma_f32_16x16x32_bf16 v[72:75], a[148:151], a[176:179], v[72:75]
  v_mfma_f32_16x16x32_bf16 v[84:87], a[152:155], a[176:179], v[84:87]
  buffer_load_dwordx4 v113, s[36:39], s65 offen offset:3072  lds
  v_mfma_f32_16x16x32_bf16 v[96:99], a[156:159], a[176:179], v[96:99]
  v_mfma_f32_16x16x32_bf16 v[16:19], a[128:131], a[180:183], v[16:19]
  v_mfma_f32_16x16x32_bf16 v[28:31], a[132:135], a[180:183], v[28:31]
  s_add_u32 m0, s68, 0
  v_mfma_f32_16x16x32_bf16 v[40:43], a[136:139], a[180:183], v[40:43]
  buffer_load_dwordx4 v104, s[32:35], s64 offen offset:0  lds
  v_mfma_f32_16x16x32_bf16 v[52:55], a[140:143], a[180:183], v[52:55]
  v_mfma_f32_16x16x32_bf16 v[64:67], a[144:147], a[180:183], v[64:67]
  v_mfma_f32_16x16x32_bf16 v[76:79], a[148:151], a[180:183], v[76:79]
  v_mfma_f32_16x16x32_bf16 v[88:91], a[152:155], a[180:183], v[88:91]
  v_mfma_f32_16x16x32_bf16 v[100:103], a[156:159], a[180:183], v[100:103]
  s_waitcnt lgkmcnt(0)
  v_mfma_f32_16x16x32_bf16 v[8:11], a[96:99], a[160:163], v[8:11]
  ds_read_b128 a[172:175], v123 offset:24576
  ds_read_b128 a[176:179], v123 offset:26624
  v_mfma_f32_16x16x32_bf16 v[20:23], a[100:103], a[160:163], v[20:23]
  ds_read_b128 a[180:183], v123 offset:28672
  v_mfma_f32_16x16x32_bf16 v[32:35], a[104:107], a[160:163], v[32:35]
  buffer_load_dwordx4 v105, s[32:35], s64 offen offset:1024  lds
  ds_read_b64_tr_b16 a[128:129], v114 offset:24576
  v_mfma_f32_16x16x32_bf16 v[44:47], a[108:111], a[160:163], v[44:47]
  ds_read_b64_tr_b16 a[130:131], v114 offset:25600
  ds_read_b64_tr_b16 a[132:133], v115 offset:24576
  v_mfma_f32_16x16x32_bf16 v[56:59], a[112:115], a[160:163], v[56:59]
  ds_read_b64_tr_b16 a[134:135], v115 offset:25600
  ds_read_b64_tr_b16 a[136:137], v116 offset:24576
  v_mfma_f32_16x16x32_bf16 v[68:71], a[116:119], a[160:163], v[68:71]
  ds_read_b64_tr_b16 a[138:139], v116 offset:25600
  v_mfma_f32_16x16x32_bf16 v[80:83], a[120:123], a[160:163], v[80:83]
  buffer_load_dwordx4 v106, s[32:35], s64 offen offset:2048  lds
  ds_read_b64_tr_b16 a[140:141], v117 offset:24576
  v_mfma_f32_16x16x32_bf16 v[92:95], a[124:127], a[160:163], v[92:95]
  ds_read_b64_tr_b16 a[142:143], v117 offset:25600
  ds_read_b64_tr_b16 a[144:145], v118 offset:24576
  v_mfma_f32_16x16x32_bf16 v[12:15], a[96:99], a[164:167], v[12:15]
  ds_read_b64_tr_b16 a[146:147], v118 offset:25600
  ds_read_b64_tr_b16 a[148:149], v119 offset:24576
  v_mfma_f32_16x16x32_bf16 v[24:27], a[100:103], a[164:167], v[24:27]
  ds_read_b64_tr_b16 a[150:151], v119 offset:25600
  v_mfma_f32_16x16x32_bf16 v[36:39], a[104:107], a[164:167], v[36:39]
  buffer_load_dwordx4 v107, s[32:35], s64 offen offset:3072  lds
  ds_read_b64_tr_b16 a[152:153], v120 offset:24576
  v_mfma_f32_16x16x32_bf16 v[48:51], a[108:111], a[164:167], v[48:51]
  ds_read_b64_tr_b16 a[154:155], v120 offset:25600
  ds_read_b64_tr_b16 a[156:157], v121 offset:24576
  v_mfma_f32_16x16x32_bf16 v[60:63], a[112:115], a[164:167], v[60:63]
  ds_read_b64_tr_b16 a[158:159], v121 offset:25600
  v_mfma_f32_16x16x32_bf16 v[72:75], a[116:119], a[164:167], v[72:75]
  s_add_u32 m0, s68, 4096
  v_mfma_f32_16x16x32_bf16 v[84:87], a[120:123], a[164:167], v[84:87]
  buffer_load_dwordx4 v108, s[32:35], s64 offen offset:0  lds
  v_mfma_f32_16x16x32_bf16 v[96:99], a[124:127], a[164:167], v[96:99]
  v_mfma_f32_16x16x32_bf16 v[16:19], a[96:99], a[168:171], v[16:19]
  v_mfma_f32_16x16x32_bf16 v[28:31], a[100:103], a[168:171], v[28:31]
  v_mfma_f32_16x16x32_bf16 v[40:43], a[104:107], a[168:171], v[40:43]
  buffer_load_dwordx4 v109, s[32:35], s64 offen offset:1024  lds
  s_bfe_u32 s4, s77, 0x40010
  v_mfma_f32_16x16x32_bf16 v[52:55], a[108:111], a[168:171], v[52:55]
  s_lshl_b32 s5, s4, 7
  s_add_u32 s64, s78, s5
  v_mfma_f32_16x16x32_bf16 v[64:67], a[112:115], a[168:171], v[64:67]
  s_lshl_b32 s4, s4, 19
  s_add_u32 s65, s79, s4
  v_mfma_f32_16x16x32_bf16 v[76:79], a[116:119], a[168:171], v[76:79]
  v_mfma_f32_16x16x32_bf16 v[88:91], a[120:123], a[168:171], v[88:91]
  v_mfma_f32_16x16x32_bf16 v[100:103], a[124:127], a[168:171], v[100:103]
  s_waitcnt vmcnt(10) lgkmcnt(0)
  s_barrier
  v_mfma_f32_16x16x32_bf16 v[8:11], a[128:131], a[172:175], v[8:11]
  ds_read_b128 a[160:163], v122 offset:49152
  ds_read_b128 a[164:167], v122 offset:51200
  v_mfma_f32_16x16x32_bf16 v[20:23], a[132:135], a[172:175], v[20:23]
  s_add_u32 m0, s69, 16384
  ds_read_b128 a[168:171], v122 offset:53248
  v_mfma_f32_16x16x32_bf16 v[32:35], a[136:139], a[172:175], v[32:35]
  buffer_load_dwordx4 v110, s[36:39], s65 offen offset:0  lds
  ds_read_b64_tr_b16 a[96:97], v114 offset:32768
  v_mfma_f32_16x16x32_bf16 v[44:47], a[140:143], a[172:175], v[44:47]
  ds_read_b64_tr_b16 a[98:99], v114 offset:33792
  ds_read_b64_tr_b16 a[100:101], v115 offset:32768
  v_mfma_f32_16x16x32_bf16 v[56:59], a[144:147], a[172:175], v[56:59]
  ds_read_b64_tr_b16 a[102:103], v115 offset:33792
  ds_read_b64_tr_b16 a[104:105], v116 offset:32768
  v_mfma_f32_16x16x32_bf16 v[68:71], a[148:151], a[172:175], v[68:71]
  ds_read_b64_tr_b16 a[106:107], v116 offset:33792
  v_mfma_f32_16x16x32_bf16 v[80:83], a[152:155], a[172:175], v[80:83]
  buffer_load_dwordx4 v111, s[36:39], s65 offen offset:1024  lds
  ds_read_b64_tr_b16 a[108:109], v117 offset:32768
  v_mfma_f32_16x16x32_bf16 v[92:95], a[156:159], a[172:175], v[92:95]
  ds_read_b64_tr_b16 a[110:111], v117 offset:33792
  ds_read_b64_tr_b16 a[112:113], v118 offset:32768
  v_mfma_f32_16x16x32_bf16 v[12:15], a[128:131], a[176:179], v[12:15]
  ds_read_b64_tr_b16 a[114:115], v118 offset:33792
  ds_read_b64_tr_b16 a[116:117], v119 offset:32768
  v_mfma_f32_16x16x32_bf16 v[24:27], a[132:135], a[176:179], v[24:27]
  ds_read_b64_tr_b16 a[118:119], v119 offset:33792
  v_mfma_f32_16x16x32_bf16 v[36:39], a[136:139], a[176:179], v[36:39]
  buffer_load_dwordx4 v112, s[36:39], s65 offen offset:2048  lds
  ds_read_b64_tr_b16 a[120:121], v120 offset:32768
  v_mfma_f32_16x16x32_bf16 v[48:51], a[140:143], a[176:179], v[48:51]
  ds_read_b64_tr_b16 a[122:123], v120 offset:33792
  ds_read_b64_tr_b16 a[124:125], v121 offset:32768
  v_mfma_f32_16x16x32_bf16 v[60:63], a[144:147], a[176:179], v[60:63]
  ds_read_b64_tr_b16 a[126:127], v121 offset:33792
  v_mfma_f32_16x16x32_bf16 v[72:75], a[148:151], a[176:179], v[72:75]
  v_mfma_f32_16x16x32_bf16 v[84:87], a[152:155], a[176:179], v[84:87]
  buffer_load_dwordx4 v113, s[36:39], s65 offen offset:3072  lds
  v_mfma_f32_16x16x32_bf16 v[96:99], a[156:159], a[176:179], v[96:99]
  v_mfma_f32_16x16x32_bf16 v[16:19], a[128:131], a[180:183], v[16:19]
  v_mfma_f32_16x16x32_bf16 v[28:31], a[132:135], a[180:183], v[28:31]
  s_add_u32 m0, s68, 24576
  v_mfma_f32_16x16x32_bf16 v[40:43], a[136:139], a[180:183], v[40:43]
  buffer_load_dwordx4 v104, s[32:35], s64 offen offset:0  lds
  v_mfma_f32_16x16x32_bf16 v[52:55], a[140:143], a[180:183], v[52:55]
  v_mfma_f32_16x16x32_bf16 v[64:67], a[144:147], a[180:183], v[64:67]
  v_mfma_f32_16x16x32_bf16 v[76:79], a[148:151], a[180:183], v[76:79]
  v_mfma_f32_16x16x32_bf16 v[88:91], a[152:155], a[180:183], v[88:91]
  v_mfma_f32_16x16x32_bf16 v[100:103], a[156:159], a[180:183], v[100:103]
  s_waitcnt lgkmcnt(0)
  v_mfma_f32_16x16x32_bf16 v[8:11], a[96:99], a[160:163], v[8:11]
  ds_read_b128 a[172:175], v123 offset:49152
  ds_read_b128 a[176:179], v123 offset:51200
  v_mfma_f32_16x16x32_bf16 v[20:23], a[100:103], a[160:163], v[20:23]
  ds_read_b128 a[180:183], v123 offset:53248
  v_mfma_f32_16x16x32_bf16 v[32:35], a[104:107], a[160:163], v[32:35]
  buffer_load_dwordx4 v105, s[32:35], s64 offen offset:1024  lds
  ds_read_b64_tr_b16 a[128:129], v114 offset:40960
  v_mfma_f32_16x16x32_bf16 v[44:47], a[108:111], a[160:163], v[44:47]
  ds_read_b64_tr_b16 a[130:131], v114 offset:41984
  ds_read_b64_tr_b16 a[132:133], v115 offset:40960
  v_mfma_f32_16x16x32_bf16 v[56:59], a[112:115], a[160:163], v[56:59]
  buffer_load_dwordx4 v106, s[32:35], s64 offen offset:2048  lds
  ds_read_b64_tr_b16 a[134:135], v115 offset:41984
  v_mfma_f32_16x16x32_bf16 v[68:71], a[116:119], a[160:163], v[68:71]
  ds_read_b64_tr_b16 a[136:137], v116 offset:40960
  ds_read_b64_tr_b16 a[138:139], v116 offset:41984
  v_mfma_f32_16x16x32_bf16 v[80:83], a[120:123], a[160:163], v[80:83]
  buffer_load_dwordx4 v107, s[32:35], s64 offen offset:3072  lds
  ds_read_b64_tr_b16 a[140:141], v117 offset:40960
  v_mfma_f32_16x16x32_bf16 v[92:95], a[124:127], a[160:163], v[92:95]
  ds_read_b64_tr_b16 a[142:143], v117 offset:41984
  ds_read_b64_tr_b16 a[144:145], v118 offset:40960
  v_mfma_f32_16x16x32_bf16 v[12:15], a[96:99], a[164:167], v[12:15]
  s_add_u32 m0, s68, 28672
  ds_read_b64_tr_b16 a[146:147], v118 offset:41984
  v_mfma_f32_16x16x32_bf16 v[24:27], a[100:103], a[164:167], v[24:27]
  buffer_load_dwordx4 v108, s[32:35], s64 offen offset:0  lds
  ds_read_b64_tr_b16 a[148:149], v119 offset:40960
  v_mfma_f32_16x16x32_bf16 v[36:39], a[104:107], a[164:167], v[36:39]
  ds_read_b64_tr_b16 a[150:151], v119 offset:41984
  ds_read_b64_tr_b16 a[152:153], v120 offset:40960
  v_mfma_f32_16x16x32_bf16 v[48:51], a[108:111], a[164:167], v[48:51]
  buffer_load_dwordx4 v109, s[32:35], s64 offen offset:1024  lds
  ds_read_b64_tr_b16 a[154:155], v120 offset:41984
  v_mfma_f32_16x16x32_bf16 v[60:63], a[112:115], a[164:167], v[60:63]
  s_bfe_u32 s4, s77, 0x40014
  s_lshl_b32 s5, s4, 7
  v_mfma_f32_16x16x32_bf16 v[72:75], a[116:119], a[164:167], v[72:75]
  s_add_u32 s64, s78, s5
  s_lshl_b32 s4, s4, 19
  v_mfma_f32_16x16x32_bf16 v[84:87], a[120:123], a[164:167], v[84:87]
  s_add_u32 s65, s79, s4
  buffer_load_dwordx4 a[0:3], v124, s[40:43], s70 offen offset:0 nt
  v_mfma_f32_16x16x32_bf16 v[96:99], a[124:127], a[164:167], v[96:99]
  ds_read_b64_tr_b16 a[156:157], v121 offset:40960
  ds_read_b64_tr_b16 a[158:159], v121 offset:41984
  v_mfma_f32_16x16x32_bf16 v[16:19], a[96:99], a[168:171], v[16:19]
  buffer_load_dwordx4 a[4:7], v124, s[40:43], s70 offen offset:1024 nt
  v_mfma_f32_16x16x32_bf16 v[28:31], a[100:103], a[168:171], v[28:31]
  v_mfma_f32_16x16x32_bf16 v[40:43], a[104:107], a[168:171], v[40:43]
  buffer_load_dwordx4 a[8:11], v124, s[40:43], s70 offen offset:2048 nt
  v_mfma_f32_16x16x32_bf16 v[52:55], a[108:111], a[168:171], v[52:55]
  v_mfma_f32_16x16x32_bf16 v[64:67], a[112:115], a[168:171], v[64:67]
  buffer_load_dwordx4 a[12:15], v124, s[40:43], s70 offen offset:3072 nt
  v_mfma_f32_16x16x32_bf16 v[76:79], a[116:119], a[168:171], v[76:79]
  v_mfma_f32_16x16x32_bf16 v[88:91], a[120:123], a[168:171], v[88:91]
  v_mfma_f32_16x16x32_bf16 v[100:103], a[124:127], a[168:171], v[100:103]
  s_waitcnt vmcnt(14) lgkmcnt(0)
  s_barrier
  v_mfma_f32_16x16x32_bf16 v[8:11], a[128:131], a[172:175], v[8:11]
  ds_read_b128 a[160:163], v122 offset:0
  ds_read_b128 a[164:167], v122 offset:2048
  v_mfma_f32_16x16x32_bf16 v[20:23], a[132:135], a[172:175], v[20:23]
  s_add_u32 m0, s69, 32768
  ds_read_b128 a[168:171], v122 offset:4096
  v_mfma_f32_16x16x32_bf16 v[32:35], a[136:139], a[172:175], v[32:35]
  buffer_load_dwordx4 v110, s[36:39], s65 offen offset:0  lds
  ds_read_b64_tr_b16 a[96:97], v114 offset:0
  v_mfma_f32_16x16x32_bf16 v[44:47], a[140:143], a[172:175], v[44:47]
  ds_read_b64_tr_b16 a[98:99], v114 offset:1024
  ds_read_b64_tr_b16 a[100:101], v115 offset:0
  v_mfma_f32_16x16x32_bf16 v[56:59], a[144:147], a[172:175], v[56:59]
  ds_read_b64_tr_b16 a[102:103], v115 offset:1024
  ds_read_b64_tr_b16 a[104:105], v116 offset:0
  v_mfma_f32_16x16x32_bf16 v[68:71], a[148:151], a[172:175], v[68:71]
  ds_read_b64_tr_b16 a[106:107], v116 offset:1024
  v_mfma_f32_16x16x32_bf16 v[80:83], a[152:155], a[172:175], v[80:83]
  buffer_load_dwordx4 v111, s[36:39], s65 offen offset:1024  lds
  ds_read_b64_tr_b16 a[108:109], v117 offset:0
  v_mfma_f32_16x16x32_bf16 v[92:95], a[156:159], a[172:175], v[92:95]
  ds_read_b64_tr_b16 a[110:111], v117 offset:1024
  ds_read_b64_tr_b16 a[112:113], v118 offset:0
  v_mfma_f32_16x16x32_bf16 v[12:15], a[128:131], a[176:179], v[12:15]
  ds_read_b64_tr_b16 a[114:115], v118 offset:1024
  ds_read_b64_tr_b16 a[116:117], v119 offset:0
  v_mfma_f32_16x16x32_bf16 v[24:27], a[132:135], a[176:179], v[24:27]
  ds_read_b64_tr_b16 a[118:119], v119 offset:1024
  v_mfma_f32_16x16x32_bf16 v[36:39], a[136:139], a[176:179], v[36:39]
  buffer_load_dwordx4 v112, s[36:39], s65 offen offset:2048  lds
  ds_read_b64_tr_b16 a[120:121], v120 offset:0
  v_mfma_f32_16x16x32_bf16 v[48:51], a[140:143], a[176:179], v[48:51]
  ds_read_b64_tr_b16 a[122:123], v120 offset:1024
  ds_read_b64_tr_b16 a[124:125], v121 offset:0
  v_mfma_f32_16x16x32_bf16 v[60:63], a[144:147], a[176:179], v[60:63]
  ds_read_b64_tr_b16 a[126:127], v121 offset:1024
  v_mfma_f32_16x16x32_bf16 v[72:75], a[148:151], a[176:179], v[72:75]
  v_mfma_f32_16x16x32_bf16 v[84:87], a[152:155], a[176:179], v[84:87]
  buffer_load_dwordx4 v113, s[36:39], s65 offen offset:3072  lds
  v_mfma_f32_16x16x32_bf16 v[96:99], a[156:159], a[176:179], v[96:99]
  v_mfma_f32_16x16x32_bf16 v[16:19], a[128:131], a[180:183], v[16:19]
  v_mfma_f32_16x16x32_bf16 v[28:31], a[132:135], a[180:183], v[28:31]
  s_add_u32 m0, s68, 49152
  v_mfma_f32_16x16x32_bf16 v[40:43], a[136:139], a[180:183], v[40:43]
  buffer_load_dwordx4 v104, s[32:35], s64 offen offset:0  lds
  v_mfma_f32_16x16x32_bf16 v[52:55], a[140:143], a[180:183], v[52:55]
  v_mfma_f32_16x16x32_bf16 v[64:67], a[144:147], a[180:183], v[64:67]
  v_mfma_f32_16x16x32_bf16 v[76:79], a[148:151], a[180:183], v[76:79]
  v_mfma_f32_16x16x32_bf16 v[88:91], a[152:155], a[180:183], v[88:91]
  v_mfma_f32_16x16x32_bf16 v[100:103], a[156:159], a[180:183], v[100:103]
  s_waitcnt lgkmcnt(0)
  v_mfma_f32_16x16x32_bf16 v[8:11], a[96:99], a[160:163], v[8:11]
  ds_read_b128 a[172:175], v123 offset:0
  ds_read_b128 a[176:179], v123 offset:2048
  v_mfma_f32_16x16x32_bf16 v[20:23], a[100:103], a[160:163], v[20:23]
  ds_read_b128 a[180:183], v123 offset:4096
  v_mfma_f32_16x16x32_bf16 v[32:35], a[104:107], a[160:163], v[32:35]
  buffer_load_dwordx4 v105, s[32:35], s64 offen offset:1024  lds
  ds_read_b64_tr_b16 a[128:129], v114 offset:8192
  v_mfma_f32_16x16x32_bf16 v[44:47], a[108:111], a[160:163], v[44:47]
  ds_read_b64_tr_b16 a[130:131], v114 offset:9216
  ds_read_b64_tr_b16 a[132:133], v115 offset:8192
  v_mfma_f32_16x16x32_bf16 v[56:59], a[112:115], a[160:163], v[56:59]
  ds_read_b64_tr_b16 a[134:135], v115 offset:9216
  ds_read_b64_tr_b16 a[136:137], v116 offset:8192
  v_mfma_f32_16x16x32_bf16 v[68:71], a[116:119], a[160:163], v[68:71]
  ds_read_b64_tr_b16 a[138:139], v116 offset:9216
  v_mfma_f32_16x16x32_bf16 v[80:83], a[120:123], a[160:163], v[80:83]
  buffer_load_dwordx4 v106, s[32:35], s64 offen offset:2048  lds
  ds_read_b64_tr_b16 a[140:141], v117 offset:8192
  v_mfma_f32_16x16x32_bf16 v[92:95], a[124:127], a[160:163], v[92:95]
  ds_read_b64_tr_b16 a[142:143], v117 offset:9216
  ds_read_b64_tr_b16 a[144:145], v118 offset:8192
  v_mfma_f32_16x16x32_bf16 v[12:15], a[96:99], a[164:167], v[12:15]
  ds_read_b64_tr_b16 a[146:147], v118 offset:9216
  ds_read_b64_tr_b16 a[148:149], v119 offset:8192
  v_mfma_f32_16x16x32_bf16 v[24:27], a[100:103], a[164:167], v[24:27]
  ds_read_b64_tr_b16 a[150:151], v119 offset:9216
  v_mfma_f32_16x16x32_bf16 v[36:39], a[104:107], a[164:167], v[36:39]
  buffer_load_dwordx4 v107, s[32:35], s64 offen offset:3072  lds
  ds_read_b64_tr_b16 a[152:153], v120 offset:8192
  v_mfma_f32_16x16x32_bf16 v[48:51], a[108:111], a[164:167], v[48:51]
  ds_read_b64_tr_b16 a[154:155], v120 offset:9216
  ds_read_b64_tr_b16 a[156:157], v121 offset:8192
  v_mfma_f32_16x16x32_bf16 v[60:63], a[112:115], a[164:167], v[60:63]
  ds_read_b64_tr_b16 a[158:159], v121 offset:9216
  v_mfma_f32_16x16x32_bf16 v[72:75], a[116:119], a[164:167], v[72:75]
  s_add_u32 m0, s68, 53248
  v_mfma_f32_16x16x32_bf16 v[84:87], a[120:123], a[164:167], v[84:87]
  buffer_load_dwordx4 v108, s[32:35], s64 offen offset:0  lds
  v_mfma_f32_16x16x32_bf16 v[96:99], a[124:127], a[164:167], v[96:99]
  v_mfma_f32_16x16x32_bf16 v[16:19], a[96:99], a[168:171], v[16:19]
  v_mfma_f32_16x16x32_bf16 v[28:31], a[100:103], a[168:171], v[28:31]
  v_mfma_f32_16x16x32_bf16 v[40:43], a[104:107], a[168:171], v[40:43]
  buffer_load_dwordx4 v109, s[32:35], s64 offen offset:1024  lds
  s_bfe_u32 s4, s77, 0x40018
  v_mfma_f32_16x16x32_bf16 v[52:55], a[108:111], a[168:171], v[52:55]
  s_lshl_b32 s5, s4, 7
  s_add_u32 s64, s78, s5
  v_mfma_f32_16x16x32_bf16 v[64:67], a[112:115], a[168:171], v[64:67]
  s_lshl_b32 s4, s4, 19
  s_add_u32 s65, s79, s4
  v_mfma_f32_16x16x32_bf16 v[76:79], a[116:119], a[168:171], v[76:79]
  v_mfma_f32_16x16x32_bf16 v[88:91], a[120:123], a[168:171], v[88:91]
  v_mfma_f32_16x16x32_bf16 v[100:103], a[124:127], a[168:171], v[100:103]
  s_waitcnt vmcnt(14) lgkmcnt(0)
  s_barrier
  v_mfma_f32_16x16x32_bf16 v[8:11], a[128:131], a[172:175], v[8:11]
  ds_read_b128 a[160:163], v122 offset:24576
  ds_read_b128 a[164:167], v122 offset:26624
  v_mfma_f32_16x16x32_bf16 v[20:23], a[132:135], a[172:175], v[20:23]
  s_add_u32 m0, s69, 0
  ds_read_b128 a[168:171], v122 offset:28672
  v_mfma_f32_16x16x32_bf16 v[32:35], a[136:139], a[172:175], v[32:35]
  buffer_load_dwordx4 v110, s[36:39], s65 offen offset:0  lds
  ds_read_b64_tr_b16 a[96:97], v114 offset:16384
  v_mfma_f32_16x16x32_bf16 v[44:47], a[140:143], a[172:175], v[44:47]
  ds_read_b64_tr_b16 a[98:99], v114 offset:17408
  ds_read_b64_tr_b16 a[100:101], v115 offset:16384
  v_mfma_f32_16x16x32_bf16 v[56:59], a[144:147], a[172:175], v[56:59]
  ds_read_b64_tr_b16 a[102:103], v115 offset:17408
  ds_read_b64_tr_b16 a[104:105], v116 offset:16384
  v_mfma_f32_16x16x32_bf16 v[68:71], a[148:151], a[172:175], v[68:71]
  ds_read_b64_tr_b16 a[106:107], v116 offset:17408
  v_mfma_f32_16x16x32_bf16 v[80:83], a[152:155], a[172:175], v[80:83]
  buffer_load_dwordx4 v111, s[36:39], s65 offen offset:1024  lds
  ds_read_b64_tr_b16 a[108:109], v117 offset:16384
  v_mfma_f32_16x16x32_bf16 v[92:95], a[156:159], a[172:175], v[92:95]
  ds_read_b64_tr_b16 a[110:111], v117 offset:17408
  ds_read_b64_tr_b16 a[112:113], v118 offset:16384
  v_mfma_f32_16x16x32_bf16 v[12:15], a[128:131], a[176:179], v[12:15]
  ds_read_b64_tr_b16 a[114:115], v118 offset:17408
  ds_read_b64_tr_b16 a[116:117], v119 offset:16384
  v_mfma_f32_16x16x32_bf16 v[24:27], a[132:135], a[176:179], v[24:27]
  ds_read_b64_tr_b16 a[118:119], v119 offset:17408
  v_mfma_f32_16x16x32_bf16 v[36:39], a[136:139], a[176:179], v[36:39]
  buffer_load_dwordx4 v112, s[36:39], s65 offen offset:2048  lds
  ds_read_b64_tr_b16 a[120:121], v120 offset:16384
  v_mfma_f32_16x16x32_bf16 v[48:51], a[140:143], a[176:179], v[48:51]
  ds_read_b64_tr_b16 a[122:123], v120 offset:17408
  ds_read_b64_tr_b16 a[124:125], v121 offset:16384
  v_mfma_f32_16x16x32_bf16 v[60:63], a[144:147], a[176:179], v[60:63]
  ds_read_b64_tr_b16 a[126:127], v121 offset:17408
  v_mfma_f32_16x16x32_bf16 v[72:75], a[148:151], a[176:179], v[72:75]
  v_mfma_f32_16x16x32_bf16 v[84:87], a[152:155], a[176:179], v[84:87]
  buffer_load_dwordx4 v113, s[36:39], s65 offen offset:3072  lds
  v_mfma_f32_16x16x32_bf16 v[96:99], a[156:159], a[176:179], v[96:99]
  v_mfma_f32_16x16x32_bf16 v[16:19], a[128:131], a[180:183], v[16:19]
  v_mfma_f32_16x16x32_bf16 v[28:31], a[132:135], a[180:183], v[28:31]
  s_add_u32 m0, s68, 0
  v_mfma_f32_16x16x32_bf16 v[40:43], a[136:139], a[180:183], v[40:43]
  buffer_load_dwordx4 v104, s[32:35], s64 offen offset:0  lds
  v_mfma_f32_16x16x32_bf16 v[52:55], a[140:143], a[180:183], v[52:55]
  v_mfma_f32_16x16x32_bf16 v[64:67], a[144:147], a[180:183], v[64:67]
  v_mfma_f32_16x16x32_bf16 v[76:79], a[148:151], a[180:183], v[76:79]
  v_mfma_f32_16x16x32_bf16 v[88:91], a[152:155], a[180:183], v[88:91]
  v_mfma_f32_16x16x32_bf16 v[100:103], a[156:159], a[180:183], v[100:103]
  s_waitcnt lgkmcnt(0)
  v_mfma_f32_16x16x32_bf16 v[8:11], a[96:99], a[160:163], v[8:11]
  ds_read_b128 a[172:175], v123 offset:24576
  ds_read_b128 a[176:179], v123 offset:26624
  v_mfma_f32_16x16x32_bf16 v[20:23], a[100:103], a[160:163], v[20:23]
  ds_read_b128 a[180:183], v123 offset:28672
  v_mfma_f32_16x16x32_bf16 v[32:35], a[104:107], a[160:163], v[32:35]
  buffer_load_dwordx4 v105, s[32:35], s64 offen offset:1024  lds
  ds_read_b64_tr_b16 a[128:129], v114 offset:24576
  v_mfma_f32_16x16x32_bf16 v[44:47], a[108:111], a[160:163], v[44:47]
  ds_read_b64_tr_b16 a[130:131], v114 offset:25600
  ds_read_b64_tr_b16 a[132:133], v115 offset:24576
  v_mfma_f32_16x16x32_bf16 v[56:59], a[112:115], a[160:163], v[56:59]
  buffer_load_dwordx4 v106, s[32:35], s64 offen offset:2048  lds
  ds_read_b64_tr_b16 a[134:135], v115 offset:25600
  v_mfma_f32_16x16x32_bf16 v[68:71], a[116:119], a[160:163], v[68:71]
  ds_read_b64_tr_b16 a[136:137], v116 offset:24576
  ds_read_b64_tr_b16 a[138:139], v116 offset:25600
  v_mfma_f32_16x16x32_bf16 v[80:83], a[120:123], a[160:163], v[80:83]
  buffer_load_dwordx4 v107, s[32:35], s64 offen offset:3072  lds
  ds_read_b64_tr_b16 a[140:141], v117 offset:24576
  v_mfma_f32_16x16x32_bf16 v[92:95], a[124:127], a[160:163], v[92:95]
  ds_read_b64_tr_b16 a[142:143], v117 offset:25600
  ds_read_b64_tr_b16 a[144:145], v118 offset:24576
  v_mfma_f32_16x16x32_bf16 v[12:15], a[96:99], a[164:167], v[12:15]
  s_add_u32 m0, s68, 4096
  ds_read_b64_tr_b16 a[146:147], v118 offset:25600
  v_mfma_f32_16x16x32_bf16 v[24:27], a[100:103], a[164:167], v[24:27]
  buffer_load_dwordx4 v108, s[32:35], s64 offen offset:0  lds
  ds_read_b64_tr_b16 a[148:149], v119 offset:24576
  v_mfma_f32_16x16x32_bf16 v[36:39], a[104:107], a[164:167], v[36:39]
  ds_read_b64_tr_b16 a[150:151], v119 offset:25600
  ds_read_b64_tr_b16 a[152:153], v120 offset:24576
  v_mfma_f32_16x16x32_bf16 v[48:51], a[108:111], a[164:167], v[48:51]
  buffer_load_dwordx4 v109, s[32:35], s64 offen offset:1024  lds
  ds_read_b64_tr_b16 a[154:155], v120 offset:25600
  v_mfma_f32_16x16x32_bf16 v[60:63], a[112:115], a[164:167], v[60:63]
  s_bfe_u32 s4, s77, 0x4001c
  s_lshl_b32 s5, s4, 7
  v_mfma_f32_16x16x32_bf16 v[72:75], a[116:119], a[164:167], v[72:75]
  s_add_u32 s64, s78, s5
  s_lshl_b32 s4, s4, 19
  v_mfma_f32_16x16x32_bf16 v[84:87], a[120:123], a[164:167], v[84:87]
  s_add_u32 s65, s79, s4
  buffer_load_dwordx4 a[16:19], v124, s[40:43], s71 offen offset:0 nt
  v_mfma_f32_16x16x32_bf16 v[96:99], a[124:127], a[164:167], v[96:99]
  ds_read_b64_tr_b16 a[156:157], v121 offset:24576
  ds_read_b64_tr_b16 a[158:159], v121 offset:25600
  v_mfma_f32_16x16x32_bf16 v[16:19], a[96:99], a[168:171], v[16:19]
  buffer_load_dwordx4 a[20:23], v124, s[40:43], s71 offen offset:1024 nt
  v_mfma_f32_16x16x32_bf16 v[28:31], a[100:103], a[168:171], v[28:31]
  v_mfma_f32_16x16x32_bf16 v[40:43], a[104:107], a[168:171], v[40:43]
  buffer_load_dwordx4 a[24:27], v124, s[40:43], s71 offen offset:2048 nt
  v_mfma_f32_16x16x32_bf16 v[52:55], a[108:111], a[168:171], v[52:55]
  v_mfma_f32_16x16x32_bf16 v[64:67], a[112:115], a[168:171], v[64:67]
  buffer_load_dwordx4 a[28:31], v124, s[40:43], s71 offen offset:3072 nt
  v_mfma_f32_16x16x32_bf16 v[76:79], a[116:119], a[168:171], v[76:79]
  v_mfma_f32_16x16x32_bf16 v[88:91], a[120:123], a[168:171], v[88:91]
  v_mfma_f32_16x16x32_bf16 v[100:103], a[124:127], a[168:171], v[100:103]
  s_waitcnt vmcnt(14) lgkmcnt(0)
  s_barrier
  v_mfma_f32_16x16x32_bf16 v[8:11], a[128:131], a[172:175], v[8:11]
  ds_read_b128 a[160:163], v122 offset:49152
  ds_read_b128 a[164:167], v122 offset:51200
  v_mfma_f32_16x16x32_bf16 v[20:23], a[132:135], a[172:175], v[20:23]
  s_add_u32 m0, s69, 16384
  ds_read_b128 a[168:171], v122 offset:53248
  v_mfma_f32_16x16x32_bf16 v[32:35], a[136:139], a[172:175], v[32:35]
  buffer_load_dwordx4 v110, s[36:39], s65 offen offset:0  lds
  ds_read_b64_tr_b16 a[96:97], v114 offset:32768
  v_mfma_f32_16x16x32_bf16 v[44:47], a[140:143], a[172:175], v[44:47]
  ds_read_b64_tr_b16 a[98:99], v114 offset:33792
  ds_read_b64_tr_b16 a[100:101], v115 offset:32768
  v_mfma_f32_16x16x32_bf16 v[56:59], a[144:147], a[172:175], v[56:59]
  ds_read_b64_tr_b16 a[102:103], v115 offset:33792
  ds_read_b64_tr_b16 a[104:105], v116 offset:32768
  v_mfma_f32_16x16x32_bf16 v[68:71], a[148:151], a[172:175], v[68:71]
  ds_read_b64_tr_b16 a[106:107], v116 offset:33792
  v_mfma_f32_16x16x32_bf16 v[80:83], a[152:155], a[172:175], v[80:83]
  buffer_load_dwordx4 v111, s[36:39], s65 offen offset:1024  lds
  ds_read_b64_tr_b16 a[108:109], v117 offset:32768
  v_mfma_f32_16x16x32_bf16 v[92:95], a[156:159], a[172:175], v[92:95]
  ds_read_b64_tr_b16 a[110:111], v117 offset:33792
  ds_read_b64_tr_b16 a[112:113], v118 offset:32768
  v_mfma_f32_16x16x32_bf16 v[12:15], a[128:131], a[176:179], v[12:15]
  ds_read_b64_tr_b16 a[114:115], v118 offset:33792
  ds_read_b64_tr_b16 a[116:117], v119 offset:32768
  v_mfma_f32_16x16x32_bf16 v[24:27], a[132:135], a[176:179], v[24:27]
  ds_read_b64_tr_b16 a[118:119], v119 offset:33792
  v_mfma_f32_16x16x32_bf16 v[36:39], a[136:139], a[176:179], v[36:39]
  buffer_load_dwordx4 v112, s[36:39], s65 offen offset:2048  lds
  ds_read_b64_tr_b16 a[120:121], v120 offset:32768
  v_mfma_f32_16x16x32_bf16 v[48:51], a[140:143], a[176:179], v[48:51]
  ds_read_b64_tr_b16 a[122:123], v120 offset:33792
  ds_read_b64_tr_b16 a[124:125], v121 offset:32768
  v_mfma_f32_16x16x32_bf16 v[60:63], a[144:147], a[176:179], v[60:63]
  ds_read_b64_tr_b16 a[126:127], v121 offset:33792
  ds_write_b128 v125, a[0:3] offset:0
  v_mfma_f32_16x16x32_bf16 v[72:75], a[148:151], a[176:179], v[72:75]
  ds_write_b128 v125, a[4:7] offset:1088
  ds_write_b128 v125, a[8:11] offset:2176
  v_mfma_f32_16x16x32_bf16 v[84:87], a[152:155], a[176:179], v[84:87]
  buffer_load_dwordx4 v113, s[36:39], s65 offen offset:3072  lds
  ds_write_b128 v125, a[12:15] offset:3264
  v_mfma_f32_16x16x32_bf16 v[96:99], a[156:159], a[176:179], v[96:99]
  v_mfma_f32_16x16x32_bf16 v[16:19], a[128:131], a[180:183], v[16:19]
  v_mfma_f32_16x16x32_bf16 v[28:31], a[132:135], a[180:183], v[28:31]
  s_add_u32 m0, s68, 24576
  v_mfma_f32_16x16x32_bf16 v[40:43], a[136:139], a[180:183], v[40:43]
  buffer_load_dwordx4 v104, s[32:35], s64 offen offset:0  lds
  v_mfma_f32_16x16x32_bf16 v[52:55], a[140:143], a[180:183], v[52:55]
  v_mfma_f32_16x16x32_bf16 v[64:67], a[144:147], a[180:183], v[64:67]
  v_mfma_f32_16x16x32_bf16 v[76:79], a[148:151], a[180:183], v[76:79]
  v_mfma_f32_16x16x32_bf16 v[88:91], a[152:155], a[180:183], v[88:91]
  v_mfma_f32_16x16x32_bf16 v[100:103], a[156:159], a[180:183], v[100:103]
  s_waitcnt lgkmcnt(0)
  v_mfma_f32_16x16x32_bf16 v[8:11], a[96:99], a[160:163], v[8:11]
  ds_read_b128 a[172:175], v123 offset:49152
  ds_read_b128 a[176:179], v123 offset:51200
  v_mfma_f32_16x16x32_bf16 v[20:23], a[100:103], a[160:163], v[20:23]
  ds_read_b128 a[180:183], v123 offset:53248
  v_mfma_f32_16x16x32_bf16 v[32:35], a[104:107], a[160:163], v[32:35]
  buffer_load_dwordx4 v105, s[32:35], s64 offen offset:1024  lds
  ds_read_b64_tr_b16 a[128:129], v114 offset:40960
  v_mfma_f32_16x16x32_bf16 v[44:47], a[108:111], a[160:163], v[44:47]
  ds_read_b64_tr_b16 a[130:131], v114 offset:41984
  ds_read_b64_tr_b16 a[132:133], v115 offset:40960
  v_mfma_f32_16x16x32_bf16 v[56:59], a[112:115], a[160:163], v[56:59]
  ds_read_b64_tr_b16 a[134:135], v115 offset:41984
  ds_read_b64_tr_b16 a[136:137], v116 offset:40960
  v_mfma_f32_16x16x32_bf16 v[68:71], a[116:119], a[160:163], v[68:71]
  ds_read_b64_tr_b16 a[138:139], v116 offset:41984
  v_mfma_f32_16x16x32_bf16 v[80:83], a[120:123], a[160:163], v[80:83]
  buffer_load_dwordx4 v106, s[32:35], s64 offen offset:2048  lds
  ds_read_b64_tr_b16 a[140:141], v117 offset:40960
  v_mfma_f32_16x16x32_bf16 v[92:95], a[124:127], a[160:163], v[92:95]
  ds_read_b64_tr_b16 a[142:143], v117 offset:41984
  ds_read_b64_tr_b16 a[144:145], v118 offset:40960
  v_mfma_f32_16x16x32_bf16 v[12:15], a[96:99], a[164:167], v[12:15]
  ds_read_b64_tr_b16 a[146:147], v118 offset:41984
  ds_read_b64_tr_b16 a[148:149], v119 offset:40960
  v_mfma_f32_16x16x32_bf16 v[24:27], a[100:103], a[164:167], v[24:27]
  ds_read_b64_tr_b16 a[150:151], v119 offset:41984
  v_mfma_f32_16x16x32_bf16 v[36:39], a[104:107], a[164:167], v[36:39]
  buffer_load_dwordx4 v107, s[32:35], s64 offen offset:3072  lds
  ds_read_b64_tr_b16 a[152:153], v120 offset:40960
  v_mfma_f32_16x16x32_bf16 v[48:51], a[108:111], a[164:167], v[48:51]
  ds_read_b64_tr_b16 a[154:155], v120 offset:41984
  ds_read_b64_tr_b16 a[156:157], v121 offset:40960
  v_mfma_f32_16x16x32_bf16 v[60:63], a[112:115], a[164:167], v[60:63]
  ds_read_b64_tr_b16 a[158:159], v121 offset:41984
  ds_read_b64 a[0:1], v127 offset:0
  v_mfma_f32_16x16x32_bf16 v[72:75], a[116:119], a[164:167], v[72:75]
  s_add_u32 m0, s68, 28672
  ds_read_b64 a[2:3], v127 offset:32
  v_mfma_f32_16x16x32_bf16 v[84:87], a[120:123], a[164:167], v[84:87]
  buffer_load_dwordx4 v108, s[32:35], s64 offen offset:0  lds
  ds_read_b64 a[4:5], v127 offset:64
  v_mfma_f32_16x16x32_bf16 v[96:99], a[124:127], a[164:167], v[96:99]
  ds_read_b64 a[6:7], v127 offset:96
  ds_read_b64 a[8:9], v127 offset:128
  v_mfma_f32_16x16x32_bf16 v[16:19], a[96:99], a[168:171], v[16:19]
  ds_read_b64 a[10:11], v127 offset:160
  ds_read_b64 a[12:13], v127 offset:192
  v_mfma_f32_16x16x32_bf16 v[28:31], a[100:103], a[168:171], v[28:31]
  ds_read_b64 a[14:15], v127 offset:224
  v_mfma_f32_16x16x32_bf16 v[40:43], a[104:107], a[168:171], v[40:43]
  buffer_load_dwordx4 v109, s[32:35], s64 offen offset:1024  lds
  s_bfe_u32 s4, s75, 0x40000
  v_mfma_f32_16x16x32_bf16 v[52:55], a[108:111], a[168:171], v[52:55]
  s_lshl_b32 s5, s4, 7
  s_add_u32 s64, s78, s5
  v_mfma_f32_16x16x32_bf16 v[64:67], a[112:115], a[168:171], v[64:67]
  s_lshl_b32 s4, s4, 19
  s_add_u32 s65, s79, s4
  v_mfma_f32_16x16x32_bf16 v[76:79], a[116:119], a[168:171], v[76:79]
  v_mfma_f32_16x16x32_bf16 v[88:91], a[120:123], a[168:171], v[88:91]
  v_mfma_f32_16x16x32_bf16 v[100:103], a[124:127], a[168:171], v[100:103]
  s_waitcnt vmcnt(14) lgkmcnt(0)
  s_barrier
  v_mfma_f32_16x16x32_bf16 v[8:11], a[128:131], a[172:175], v[8:11]
  ds_read_b128 a[160:163], v122 offset:0
  ds_read_b128 a[164:167], v122 offset:2048
  v_mfma_f32_16x16x32_bf16 v[20:23], a[132:135], a[172:175], v[20:23]
  s_add_u32 m0, s69, 32768
  ds_read_b128 a[168:171], v122 offset:4096
  v_mfma_f32_16x16x32_bf16 v[32:35], a[136:139], a[172:175], v[32:35]
  buffer_load_dwordx4 v110, s[36:39], s65 offen offset:0  lds
  ds_read_b64_tr_b16 a[96:97], v114 offset:0
  v_mfma_f32_16x16x32_bf16 v[44:47], a[140:143], a[172:175], v[44:47]
  ds_read_b64_tr_b16 a[98:99], v114 offset:1024
  ds_read_b64_tr_b16 a[100:101], v115 offset:0
  v_mfma_f32_16x16x32_bf16 v[56:59], a[144:147], a[172:175], v[56:59]
  ds_read_b64_tr_b16 a[102:103], v115 offset:1024
  ds_read_b64_tr_b16 a[104:105], v116 offset:0
  v_mfma_f32_16x16x32_bf16 v[68:71], a[148:151], a[172:175], v[68:71]
  ds_read_b64_tr_b16 a[106:107], v116 offset:1024
  v_mfma_f32_16x16x32_bf16 v[80:83], a[152:155], a[172:175], v[80:83]
  buffer_load_dwordx4 v111, s[36:39], s65 offen offset:1024  lds
  ds_read_b64_tr_b16 a[108:109], v117 offset:0
  v_mfma_f32_16x16x32_bf16 v[92:95], a[156:159], a[172:175], v[92:95]
  ds_read_b64_tr_b16 a[110:111], v117 offset:1024
  ds_read_b64_tr_b16 a[112:113], v118 offset:0
  v_mfma_f32_16x16x32_bf16 v[12:15], a[128:131], a[176:179], v[12:15]
  ds_read_b64_tr_b16 a[114:115], v118 offset:1024
  ds_read_b64_tr_b16 a[116:117], v119 offset:0
  v_mfma_f32_16x16x32_bf16 v[24:27], a[132:135], a[176:179], v[24:27]
  ds_read_b64_tr_b16 a[118:119], v119 offset:1024
  v_mfma_f32_16x16x32_bf16 v[36:39], a[136:139], a[176:179], v[36:39]
  buffer_load_dwordx4 v112, s[36:39], s65 offen offset:2048  lds
  ds_read_b64_tr_b16 a[120:121], v120 offset:0
  v_mfma_f32_16x16x32_bf16 v[48:51], a[140:143], a[176:179], v[48:51]
  ds_read_b64_tr_b16 a[122:123], v120 offset:1024
  ds_read_b64_tr_b16 a[124:125], v121 offset:0
  v_mfma_f32_16x16x32_bf16 v[60:63], a[144:147], a[176:179], v[60:63]
  ds_read_b64_tr_b16 a[126:127], v121 offset:1024
  v_mfma_f32_16x16x32_bf16 v[72:75], a[148:151], a[176:179], v[72:75]
  v_mfma_f32_16x16x32_bf16 v[84:87], a[152:155], a[176:179], v[84:87]
  buffer_load_dwordx4 v113, s[36:39], s65 offen offset:3072  lds
  v_mfma_f32_16x16x32_bf16 v[96:99], a[156:159], a[176:179], v[96:99]
  v_mfma_f32_16x16x32_bf16 v[16:19], a[128:131], a[180:183], v[16:19]
  v_mfma_f32_16x16x32_bf16 v[28:31], a[132:135], a[180:183], v[28:31]
  s_add_u32 m0, s68, 49152
  v_mfma_f32_16x16x32_bf16 v[40:43], a[136:139], a[180:183], v[40:43]
  buffer_load_dwordx4 v104, s[32:35], s64 offen offset:0  lds
  v_mfma_f32_16x16x32_bf16 v[52:55], a[140:143], a[180:183], v[52:55]
  v_mfma_f32_16x16x32_bf16 v[64:67], a[144:147], a[180:183], v[64:67]
  v_mfma_f32_16x16x32_bf16 v[76:79], a[148:151], a[180:183], v[76:79]
  v_mfma_f32_16x16x32_bf16 v[88:91], a[152:155], a[180:183], v[88:91]
  v_mfma_f32_16x16x32_bf16 v[100:103], a[156:159], a[180:183], v[100:103]
  s_waitcnt lgkmcnt(0)
  v_mfma_f32_16x16x32_bf16 v[8:11], a[96:99], a[160:163], v[8:11]
  ds_read_b128 a[172:175], v123 offset:0
  ds_read_b128 a[176:179], v123 offset:2048
  v_mfma_f32_16x16x32_bf16 v[20:23], a[100:103], a[160:163], v[20:23]
  ds_read_b128 a[180:183], v123 offset:4096
  v_mfma_f32_16x16x32_bf16 v[32:35], a[104:107], a[160:163], v[32:35]
  buffer_load_dwordx4 v105, s[32:35], s64 offen offset:1024  lds
  ds_read_b64_tr_b16 a[128:129], v114 offset:8192
  v_mfma_f32_16x16x32_bf16 v[44:47], a[108:111], a[160:163], v[44:47]
  ds_read_b64_tr_b16 a[130:131], v114 offset:9216
  ds_read_b64_tr_b16 a[132:133], v115 offset:8192
  v_mfma_f32_16x16x32_bf16 v[56:59], a[112:115], a[160:163], v[56:59]
  buffer_load_dwordx4 v106, s[32:35], s64 offen offset:2048  lds
  ds_read_b64_tr_b16 a[134:135], v115 offset:9216
  v_mfma_f32_16x16x32_bf16 v[68:71], a[116:119], a[160:163], v[68:71]
  ds_read_b64_tr_b16 a[136:137], v116 offset:8192
  ds_read_b64_tr_b16 a[138:139], v116 offset:9216
  v_mfma_f32_16x16x32_bf16 v[80:83], a[120:123], a[160:163], v[80:83]
  buffer_load_dwordx4 v107, s[32:35], s64 offen offset:3072  lds
  ds_read_b64_tr_b16 a[140:141], v117 offset:8192
  v_mfma_f32_16x16x32_bf16 v[92:95], a[124:127], a[160:163], v[92:95]
  ds_read_b64_tr_b16 a[142:143], v117 offset:9216
  ds_read_b64_tr_b16 a[144:145], v118 offset:8192
  v_mfma_f32_16x16x32_bf16 v[12:15], a[96:99], a[164:167], v[12:15]
  s_add_u32 m0, s68, 53248
  ds_read_b64_tr_b16 a[146:147], v118 offset:9216
  v_mfma_f32_16x16x32_bf16 v[24:27], a[100:103], a[164:167], v[24:27]
  buffer_load_dwordx4 v108, s[32:35], s64 offen offset:0  lds
  ds_read_b64_tr_b16 a[148:149], v119 offset:8192
  v_mfma_f32_16x16x32_bf16 v[36:39], a[104:107], a[164:167], v[36:39]
  ds_read_b64_tr_b16 a[150:151], v119 offset:9216
  ds_read_b64_tr_b16 a[152:153], v120 offset:8192
  v_mfma_f32_16x16x32_bf16 v[48:51], a[108:111], a[164:167], v[48:51]
  buffer_load_dwordx4 v109, s[32:35], s64 offen offset:1024  lds
  ds_read_b64_tr_b16 a[154:155], v120 offset:9216
  v_mfma_f32_16x16x32_bf16 v[60:63], a[112:115], a[164:167], v[60:63]
  s_bfe_u32 s4, s75, 0x40004
  s_lshl_b32 s5, s4, 7
  v_mfma_f32_16x16x32_bf16 v[72:75], a[116:119], a[164:167], v[72:75]
  s_add_u32 s64, s78, s5
  s_lshl_b32 s4, s4, 19
  v_mfma_f32_16x16x32_bf16 v[84:87], a[120:123], a[164:167], v[84:87]
  s_add_u32 s65, s79, s4
  buffer_load_dwordx4 a[32:35], v124, s[40:43], s72 offen offset:0 nt
  v_mfma_f32_16x16x32_bf16 v[96:99], a[124:127], a[164:167], v[96:99]
  ds_read_b64_tr_b16 a[156:157], v121 offset:8192
  ds_read_b64_tr_b16 a[158:159], v121 offset:9216
  v_mfma_f32_16x16x32_bf16 v[16:19], a[96:99], a[168:171], v[16:19]
  buffer_load_dwordx4 a[36:39], v124, s[40:43], s72 offen offset:1024 nt
  v_mfma_f32_16x16x32_bf16 v[28:31], a[100:103], a[168:171], v[28:31]
  v_mfma_f32_16x16x32_bf16 v[40:43], a[104:107], a[168:171], v[40:43]
  buffer_load_dwordx4 a[40:43], v124, s[40:43], s72 offen offset:2048 nt
  v_mfma_f32_16x16x32_bf16 v[52:55], a[108:111], a[168:171], v[52:55]
  v_mfma_f32_16x16x32_bf16 v[64:67], a[112:115], a[168:171], v[64:67]
  buffer_load_dwordx4 a[44:47], v124, s[40:43], s72 offen offset:3072 nt
  v_mfma_f32_16x16x32_bf16 v[76:79], a[116:119], a[168:171], v[76:79]
  v_mfma_f32_16x16x32_bf16 v[88:91], a[120:123], a[168:171], v[88:91]
  v_mfma_f32_16x16x32_bf16 v[100:103], a[124:127], a[168:171], v[100:103]
  s_waitcnt vmcnt(14) lgkmcnt(0)
  s_barrier
  v_mfma_f32_16x16x32_bf16 v[8:11], a[128:131], a[172:175], v[8:11]
  ds_read_b128 a[160:163], v122 offset:24576
  ds_read_b128 a[164:167], v122 offset:26624
  v_mfma_f32_16x16x32_bf16 v[20:23], a[132:135], a[172:175], v[20:23]
  s_add_u32 m0, s69, 0
  ds_read_b128 a[168:171], v122 offset:28672
  v_mfma_f32_16x16x32_bf16 v[32:35], a[136:139], a[172:175], v[32:35]
  buffer_load_dwordx4 v110, s[36:39], s65 offen offset:0  lds
  ds_read_b64_tr_b16 a[96:97], v114 offset:16384
  v_mfma_f32_16x16x32_bf16 v[44:47], a[140:143], a[172:175], v[44:47]
  ds_read_b64_tr_b16 a[98:99], v114 offset:17408
  ds_read_b64_tr_b16 a[100:101], v115 offset:16384
  v_mfma_f32_16x16x32_bf16 v[56:59], a[144:147], a[172:175], v[56:59]
  ds_read_b64_tr_b16 a[102:103], v115 offset:17408
  ds_read_b64_tr_b16 a[104:105], v116 offset:16384
  v_mfma_f32_16x16x32_bf16 v[68:71], a[148:151], a[172:175], v[68:71]
  ds_read_b64_tr_b16 a[106:107], v116 offset:17408
  v_mfma_f32_16x16x32_bf16 v[80:83], a[152:155], a[172:175], v[80:83]
  buffer_load_dwordx4 v111, s[36:39], s65 offen offset:1024  lds
  ds_read_b64_tr_b16 a[108:109], v117 offset:16384
  v_mfma_f32_16x16x32_bf16 v[92:95], a[156:159], a[172:175], v[92:95]
  ds_read_b64_tr_b16 a[110:111], v117 offset:17408
  ds_read_b64_tr_b16 a[112:113], v118 offset:16384
  v_mfma_f32_16x16x32_bf16 v[12:15], a[128:131], a[176:179], v[12:15]
  ds_read_b64_tr_b16 a[114:115], v118 offset:17408
  ds_read_b64_tr_b16 a[116:117], v119 offset:16384
  v_mfma_f32_16x16x32_bf16 v[24:27], a[132:135], a[176:179], v[24:27]
  ds_read_b64_tr_b16 a[118:119], v119 offset:17408
  v_mfma_f32_16x16x32_bf16 v[36:39], a[136:139], a[176:179], v[36:39]
  buffer_load_dwordx4 v112, s[36:39], s65 offen offset:2048  lds
  ds_read_b64_tr_b16 a[120:121], v120 offset:16384
  v_mfma_f32_16x16x32_bf16 v[48:51], a[140:143], a[176:179], v[48:51]
  ds_read_b64_tr_b16 a[122:123], v120 offset:17408
  ds_read_b64_tr_b16 a[124:125], v121 offset:16384
  v_mfma_f32_16x16x32_bf16 v[60:63], a[144:147], a[176:179], v[60:63]
  ds_read_b64_tr_b16 a[126:127], v121 offset:17408
  ds_write_b128 v125, a[16:19] offset:0
  v_mfma_f32_16x16x32_bf16 v[72:75], a[148:151], a[176:179], v[72:75]
  ds_write_b128 v125, a[20:23] offset:1088
  ds_write_b128 v125, a[24:27] offset:2176
  v_mfma_f32_16x16x32_bf16 v[84:87], a[152:155], a[176:179], v[84:87]
  buffer_load_dwordx4 v113, s[36:39], s65 offen offset:3072  lds
  ds_write_b128 v125, a[28:31] offset:3264
  v_mfma_f32_16x16x32_bf16 v[96:99], a[156:159], a[176:179], v[96:99]
  v_mfma_f32_16x16x32_bf16 v[16:19], a[128:131], a[180:183], v[16:19]
  v_mfma_f32_16x16x32_bf16 v[28:31], a[132:135], a[180:183], v[28:31]
  s_add_u32 m0, s68, 0
  v_mfma_f32_16x16x32_bf16 v[40:43], a[136:139], a[180:183], v[40:43]
  buffer_load_dwordx4 v104, s[32:35], s64 offen offset:0  lds
  v_mfma_f32_16x16x32_bf16 v[52:55], a[140:143], a[180:183], v[52:55]
  v_mfma_f32_16x16x32_bf16 v[64:67], a[144:147], a[180:183], v[64:67]
  v_mfma_f32_16x16x32_bf16 v[76:79], a[148:151], a[180:183], v[76:79]
  v_mfma_f32_16x16x32_bf16 v[88:91], a[152:155], a[180:183], v[88:91]
  v_mfma_f32_16x16x32_bf16 v[100:103], a[156:159], a[180:183], v[100:103]
  s_waitcnt lgkmcnt(0)
  v_mfma_f32_16x16x32_bf16 v[8:11], a[96:99], a[160:163], v[8:11]
  ds_read_b128 a[172:175], v123 offset:24576
  ds_read_b128 a[176:179], v123 offset:26624
  v_mfma_f32_16x16x32_bf16 v[20:23], a[100:103], a[160:163], v[20:23]
  ds_read_b128 a[180:183], v123 offset:28672
  v_mfma_f32_16x16x32_bf16 v[32:35], a[104:107], a[160:163], v[32:35]
  buffer_load_dwordx4 v105, s[32:35], s64 offen offset:1024  lds
  ds_read_b64_tr_b16 a[128:129], v114 offset:24576
  v_mfma_f32_16x16x32_bf16 v[44:47], a[108:111], a[160:163], v[44:47]
  ds_read_b64_tr_b16 a[130:131], v114 offset:25600
  ds_read_b64_tr_b16 a[132:133], v115 offset:24576
  v_mfma_f32_16x16x32_bf16 v[56:59], a[112:115], a[160:163], v[56:59]
  ds_read_b64_tr_b16 a[134:135], v115 offset:25600
  ds_read_b64_tr_b16 a[136:137], v116 offset:24576
  v_mfma_f32_16x16x32_bf16 v[68:71], a[116:119], a[160:163], v[68:71]
  ds_read_b64_tr_b16 a[138:139], v116 offset:25600
  v_mfma_f32_16x16x32_bf16 v[80:83], a[120:123], a[160:163], v[80:83]
  buffer_load_dwordx4 v106, s[32:35], s64 offen offset:2048  lds
  ds_read_b64_tr_b16 a[140:141], v117 offset:24576
  v_mfma_f32_16x16x32_bf16 v[92:95], a[124:127], a[160:163], v[92:95]
  ds_read_b64_tr_b16 a[142:143], v117 offset:25600
  ds_read_b64_tr_b16 a[144:145], v118 offset:24576
  v_mfma_f32_16x16x32_bf16 v[12:15], a[96:99], a[164:167], v[12:15]
  ds_read_b64_tr_b16 a[146:147], v118 offset:25600
  ds_read_b64_tr_b16 a[148:149], v119 offset:24576
  v_mfma_f32_16x16x32_bf16 v[24:27], a[100:103], a[164:167], v[24:27]
  ds_read_b64_tr_b16 a[150:151], v119 offset:25600
  v_mfma_f32_16x16x32_bf16 v[36:39], a[104:107], a[164:167], v[36:39]
  buffer_load_dwordx4 v107, s[32:35], s64 offen offset:3072  lds
  ds_read_b64_tr_b16 a[152:153], v120 offset:24576
  v_mfma_f32_16x16x32_bf16 v[48:51], a[108:111], a[164:167], v[48:51]
  ds_read_b64_tr_b16 a[154:155], v120 offset:25600
  ds_read_b64_tr_b16 a[156:157], v121 offset:24576
  v_mfma_f32_16x16x32_bf16 v[60:63], a[112:115], a[164:167], v[60:63]
  ds_read_b64_tr_b16 a[158:159], v121 offset:25600
  ds_read_b64 a[16:17], v127 offset:0
  v_mfma_f32_16x16x32_bf16 v[72:75], a[116:119], a[164:167], v[72:75]
  s_add_u32 m0, s68, 4096
  ds_read_b64 a[18:19], v127 offset:32
  v_mfma_f32_16x16x32_bf16 v[84:87], a[120:123], a[164:167], v[84:87]
  buffer_load_dwordx4 v108, s[32:35], s64 offen offset:0  lds
  ds_read_b64 a[20:21], v127 offset:64
  v_mfma_f32_16x16x32_bf16 v[96:99], a[124:127], a[164:167], v[96:99]
  ds_read_b64 a[22:23], v127 offset:96
  ds_read_b64 a[24:25], v127 offset:128
  v_mfma_f32_16x16x32_bf16 v[16:19], a[96:99], a[168:171], v[16:19]
  ds_read_b64 a[26:27], v127 offset:160
  ds_read_b64 a[28:29], v127 offset:192
  v_mfma_f32_16x16x32_bf16 v[28:31], a[100:103], a[168:171], v[28:31]
  ds_read_b64 a[30:31], v127 offset:224
  v_mfma_f32_16x16x32_bf16 v[40:43], a[104:107], a[168:171], v[40:43]
  buffer_load_dwordx4 v109, s[32:35], s64 offen offset:1024  lds
  s_bfe_u32 s4, s75, 0x40008
  v_mfma_f32_16x16x32_bf16 v[52:55], a[108:111], a[168:171], v[52:55]
  s_lshl_b32 s5, s4, 7
  s_add_u32 s64, s78, s5
  v_mfma_f32_16x16x32_bf16 v[64:67], a[112:115], a[168:171], v[64:67]
  s_lshl_b32 s4, s4, 19
  s_add_u32 s65, s79, s4
  v_mfma_f32_16x16x32_bf16 v[76:79], a[116:119], a[168:171], v[76:79]
  v_mfma_f32_16x16x32_bf16 v[88:91], a[120:123], a[168:171], v[88:91]
  v_mfma_f32_16x16x32_bf16 v[100:103], a[124:127], a[168:171], v[100:103]
  s_waitcnt vmcnt(14) lgkmcnt(0)
  s_barrier
  v_mfma_f32_16x16x32_bf16 v[8:11], a[128:131], a[172:175], v[8:11]
  ds_read_b128 a[160:163], v122 offset:49152
  ds_read_b128 a[164:167], v122 offset:51200
  v_mfma_f32_16x16x32_bf16 v[20:23], a[132:135], a[172:175], v[20:23]
  s_add_u32 m0, s69, 16384
  ds_read_b128 a[168:171], v122 offset:53248
  v_mfma_f32_16x16x32_bf16 v[32:35], a[136:139], a[172:175], v[32:35]
  buffer_load_dwordx4 v110, s[36:39], s65 offen offset:0  lds
  ds_read_b64_tr_b16 a[96:97], v114 offset:32768
  v_mfma_f32_16x16x32_bf16 v[44:47], a[140:143], a[172:175], v[44:47]
  ds_read_b64_tr_b16 a[98:99], v114 offset:33792
  ds_read_b64_tr_b16 a[100:101], v115 offset:32768
  v_mfma_f32_16x16x32_bf16 v[56:59], a[144:147], a[172:175], v[56:59]
  ds_read_b64_tr_b16 a[102:103], v115 offset:33792
  ds_read_b64_tr_b16 a[104:105], v116 offset:32768
  v_mfma_f32_16x16x32_bf16 v[68:71], a[148:151], a[172:175], v[68:71]
  ds_read_b64_tr_b16 a[106:107], v116 offset:33792
  v_mfma_f32_16x16x32_bf16 v[80:83], a[152:155], a[172:175], v[80:83]
  buffer_load_dwordx4 v111, s[36:39], s65 offen offset:1024  lds
  ds_read_b64_tr_b16 a[108:109], v117 offset:32768
  v_mfma_f32_16x16x32_bf16 v[92:95], a[156:159], a[172:175], v[92:95]
  ds_read_b64_tr_b16 a[110:111], v117 offset:33792
  ds_read_b64_tr_b16 a[112:113], v118 offset:32768
  v_mfma_f32_16x16x32_bf16 v[12:15], a[128:131], a[176:179], v[12:15]
  ds_read_b64_tr_b16 a[114:115], v118 offset:33792
  ds_read_b64_tr_b16 a[116:117], v119 offset:32768
  v_mfma_f32_16x16x32_bf16 v[24:27], a[132:135], a[176:179], v[24:27]
  ds_read_b64_tr_b16 a[118:119], v119 offset:33792
  v_mfma_f32_16x16x32_bf16 v[36:39], a[136:139], a[176:179], v[36:39]
  buffer_load_dwordx4 v112, s[36:39], s65 offen offset:2048  lds
  ds_read_b64_tr_b16 a[120:121], v120 offset:32768
  v_mfma_f32_16x16x32_bf16 v[48:51], a[140:143], a[176:179], v[48:51]
  ds_read_b64_tr_b16 a[122:123], v120 offset:33792
  ds_read_b64_tr_b16 a[124:125], v121 offset:32768
  v_mfma_f32_16x16x32_bf16 v[60:63], a[144:147], a[176:179], v[60:63]
  ds_read_b64_tr_b16 a[126:127], v121 offset:33792
  v_mfma_f32_16x16x32_bf16 v[72:75], a[148:151], a[176:179], v[72:75]
  v_mfma_f32_16x16x32_bf16 v[84:87], a[152:155], a[176:179], v[84:87]
  buffer_load_dwordx4 v113, s[36:39], s65 offen offset:3072  lds
  v_mfma_f32_16x16x32_bf16 v[96:99], a[156:159], a[176:179], v[96:99]
  v_mfma_f32_16x16x32_bf16 v[16:19], a[128:131], a[180:183], v[16:19]
  v_mfma_f32_16x16x32_bf16 v[28:31], a[132:135], a[180:183], v[28:31]
  s_add_u32 m0, s68, 24576
  v_mfma_f32_16x16x32_bf16 v[40:43], a[136:139], a[180:183], v[40:43]
  buffer_load_dwordx4 v104, s[32:35], s64 offen offset:0  lds
  v_mfma_f32_16x16x32_bf16 v[52:55], a[140:143], a[180:183], v[52:55]
  v_mfma_f32_16x16x32_bf16 v[64:67], a[144:147], a[180:183], v[64:67]
  v_mfma_f32_16x16x32_bf16 v[76:79], a[148:151], a[180:183], v[76:79]
  v_mfma_f32_16x16x32_bf16 v[88:91], a[152:155], a[180:183], v[88:91]
  v_mfma_f32_16x16x32_bf16 v[100:103], a[156:159], a[180:183], v[100:103]
  s_waitcnt lgkmcnt(0)
  v_mfma_f32_16x16x32_bf16 v[8:11], a[96:99], a[160:163], v[8:11]
  ds_read_b128 a[172:175], v123 offset:49152
  ds_read_b128 a[176:179], v123 offset:51200
  v_mfma_f32_16x16x32_bf16 v[20:23], a[100:103], a[160:163], v[20:23]
  ds_read_b128 a[180:183], v123 offset:53248
  v_mfma_f32_16x16x32_bf16 v[32:35], a[104:107], a[160:163], v[32:35]
  buffer_load_dwordx4 v105, s[32:35], s64 offen offset:1024  lds
  ds_read_b64_tr_b16 a[128:129], v114 offset:40960
  v_mfma_f32_16x16x32_bf16 v[44:47], a[108:111], a[160:163], v[44:47]
  ds_read_b64_tr_b16 a[130:131], v114 offset:41984
  ds_read_b64_tr_b16 a[132:133], v115 offset:40960
  v_mfma_f32_16x16x32_bf16 v[56:59], a[112:115], a[160:163], v[56:59]
  buffer_load_dwordx4 v106, s[32:35], s64 offen offset:2048  lds
  ds_read_b64_tr_b16 a[134:135], v115 offset:41984
  v_mfma_f32_16x16x32_bf16 v[68:71], a[116:119], a[160:163], v[68:71]
  ds_read_b64_tr_b16 a[136:137], v116 offset:40960
  ds_read_b64_tr_b16 a[138:139], v116 offset:41984
  v_mfma_f32_16x16x32_bf16 v[80:83], a[120:123], a[160:163], v[80:83]
  buffer_load_dwordx4 v107, s[32:35], s64 offen offset:3072  lds
  ds_read_b64_tr_b16 a[140:141], v117 offset:40960
  v_mfma_f32_16x16x32_bf16 v[92:95], a[124:127], a[160:163], v[92:95]
  ds_read_b64_tr_b16 a[142:143], v117 offset:41984
  ds_read_b64_tr_b16 a[144:145], v118 offset:40960
  v_mfma_f32_16x16x32_bf16 v[12:15], a[96:99], a[164:167], v[12:15]
  s_add_u32 m0, s68, 28672
  ds_read_b64_tr_b16 a[146:147], v118 offset:41984
  v_mfma_f32_16x16x32_bf16 v[24:27], a[100:103], a[164:167], v[24:27]
  buffer_load_dwordx4 v108, s[32:35], s64 offen offset:0  lds
  ds_read_b64_tr_b16 a[148:149], v119 offset:40960
  v_mfma_f32_16x16x32_bf16 v[36:39], a[104:107], a[164:167], v[36:39]
  ds_read_b64_tr_b16 a[150:151], v119 offset:41984
  ds_read_b64_tr_b16 a[152:153], v120 offset:40960
  v_mfma_f32_16x16x32_bf16 v[48:51], a[108:111], a[164:167], v[48:51]
  buffer_load_dwordx4 v109, s[32:35], s64 offen offset:1024  lds
  ds_read_b64_tr_b16 a[154:155], v120 offset:41984
  v_mfma_f32_16x16x32_bf16 v[60:63], a[112:115], a[164:167], v[60:63]
  s_bfe_u32 s4, s75, 0x4000c
  s_lshl_b32 s5, s4, 7
  v_mfma_f32_16x16x32_bf16 v[72:75], a[116:119], a[164:167], v[72:75]
  s_add_u32 s64, s78, s5
  s_lshl_b32 s4, s4, 19
  v_mfma_f32_16x16x32_bf16 v[84:87], a[120:123], a[164:167], v[84:87]
  s_add_u32 s65, s79, s4
  buffer_load_dwordx4 a[48:51], v124, s[44:47], s70 offen offset:0 nt
  v_mfma_f32_16x16x32_bf16 v[96:99], a[124:127], a[164:167], v[96:99]
  ds_read_b64_tr_b16 a[156:157], v121 offset:40960
  ds_read_b64_tr_b16 a[158:159], v121 offset:41984
  v_mfma_f32_16x16x32_bf16 v[16:19], a[96:99], a[168:171], v[16:19]
  buffer_load_dwordx4 a[52:55], v124, s[44:47], s70 offen offset:1024 nt
  v_mfma_f32_16x16x32_bf16 v[28:31], a[100:103], a[168:171], v[28:31]
  v_mfma_f32_16x16x32_bf16 v[40:43], a[104:107], a[168:171], v[40:43]
  buffer_load_dwordx4 a[56:59], v124, s[44:47], s70 offen offset:2048 nt
  v_mfma_f32_16x16x32_bf16 v[52:55], a[108:111], a[168:171], v[52:55]
  v_mfma_f32_16x16x32_bf16 v[64:67], a[112:115], a[168:171], v[64:67]
  buffer_load_dwordx4 a[60:63], v124, s[44:47], s70 offen offset:3072 nt
  v_mfma_f32_16x16x32_bf16 v[76:79], a[116:119], a[168:171], v[76:79]
  v_mfma_f32_16x16x32_bf16 v[88:91], a[120:123], a[168:171], v[88:91]
  v_mfma_f32_16x16x32_bf16 v[100:103], a[124:127], a[168:171], v[100:103]
  s_waitcnt vmcnt(14) lgkmcnt(0)
  s_barrier
  v_mfma_f32_16x16x32_bf16 v[8:11], a[128:131], a[172:175], v[8:11]
  ds_read_b128 a[160:163], v122 offset:0
  ds_read_b128 a[164:167], v122 offset:2048
  v_mfma_f32_16x16x32_bf16 v[20:23], a[132:135], a[172:175], v[20:23]
  s_add_u32 m0, s69, 32768
  ds_read_b128 a[168:171], v122 offset:4096
  v_mfma_f32_16x16x32_bf16 v[32:35], a[136:139], a[172:175], v[32:35]
  buffer_load_dwordx4 v110, s[36:39], s65 offen offset:0  lds
  ds_read_b64_tr_b16 a[96:97], v114 offset:0
  v_mfma_f32_16x16x32_bf16 v[44:47], a[140:143], a[172:175], v[44:47]
  ds_read_b64_tr_b16 a[98:99], v114 offset:1024
  ds_read_b64_tr_b16 a[100:101], v115 offset:0
  v_mfma_f32_16x16x32_bf16 v[56:59], a[144:147], a[172:175], v[56:59]
  ds_read_b64_tr_b16 a[102:103], v115 offset:1024
  ds_read_b64_tr_b16 a[104:105], v116 offset:0
  v_mfma_f32_16x16x32_bf16 v[68:71], a[148:151], a[172:175], v[68:71]
  ds_read_b64_tr_b16 a[106:107], v116 offset:1024
  v_mfma_f32_16x16x32_bf16 v[80:83], a[152:155], a[172:175], v[80:83]
  buffer_load_dwordx4 v111, s[36:39], s65 offen offset:1024  lds
  ds_read_b64_tr_b16 a[108:109], v117 offset:0
  v_mfma_f32_16x16x32_bf16 v[92:95], a[156:159], a[172:175], v[92:95]
  ds_read_b64_tr_b16 a[110:111], v117 offset:1024
  ds_read_b64_tr_b16 a[112:113], v118 offset:0
  v_mfma_f32_16x16x32_bf16 v[12:15], a[128:131], a[176:179], v[12:15]
  ds_read_b64_tr_b16 a[114:115], v118 offset:1024
  ds_read_b64_tr_b16 a[116:117], v119 offset:0
  v_mfma_f32_16x16x32_bf16 v[24:27], a[132:135], a[176:179], v[24:27]
  ds_read_b64_tr_b16 a[118:119], v119 offset:1024
  v_mfma_f32_16x16x32_bf16 v[36:39], a[136:139], a[176:179], v[36:39]
  buffer_load_dwordx4 v112, s[36:39], s65 offen offset:2048  lds
  ds_read_b64_tr_b16 a[120:121], v120 offset:0
  v_mfma_f32_16x16x32_bf16 v[48:51], a[140:143], a[176:179], v[48:51]
  ds_read_b64_tr_b16 a[122:123], v120 offset:1024
  ds_read_b64_tr_b16 a[124:125], v121 offset:0
  v_mfma_f32_16x16x32_bf16 v[60:63], a[144:147], a[176:179], v[60:63]
  ds_read_b64_tr_b16 a[126:127], v121 offset:1024
  ds_write_b128 v125, a[32:35] offset:0
  v_mfma_f32_16x16x32_bf16 v[72:75], a[148:151], a[176:179], v[72:75]
  ds_write_b128 v125, a[36:39] offset:1088
  ds_write_b128 v125, a[40:43] offset:2176
  v_mfma_f32_16x16x32_bf16 v[84:87], a[152:155], a[176:179], v[84:87]
  buffer_load_dwordx4 v113, s[36:39], s65 offen offset:3072  lds
  ds_write_b128 v125, a[44:47] offset:3264
  v_mfma_f32_16x16x32_bf16 v[96:99], a[156:159], a[176:179], v[96:99]
  v_mfma_f32_16x16x32_bf16 v[16:19], a[128:131], a[180:183], v[16:19]
  v_mfma_f32_16x16x32_bf16 v[28:31], a[132:135], a[180:183], v[28:31]
  s_add_u32 m0, s68, 49152
  v_mfma_f32_16x16x32_bf16 v[40:43], a[136:139], a[180:183], v[40:43]
  buffer_load_dwordx4 v104, s[32:35], s64 offen offset:0  lds
  v_mfma_f32_16x16x32_bf16 v[52:55], a[140:143], a[180:183], v[52:55]
  v_mfma_f32_16x16x32_bf16 v[64:67], a[144:147], a[180:183], v[64:67]
  v_mfma_f32_16x16x32_bf16 v[76:79], a[148:151], a[180:183], v[76:79]
  v_mfma_f32_16x16x32_bf16 v[88:91], a[152:155], a[180:183], v[88:91]
  v_mfma_f32_16x16x32_bf16 v[100:103], a[156:159], a[180:183], v[100:103]
  s_waitcnt lgkmcnt(0)
  v_mfma_f32_16x16x32_bf16 v[8:11], a[96:99], a[160:163], v[8:11]
  ds_read_b128 a[172:175], v123 offset:0
  ds_read_b128 a[176:179], v123 offset:2048
  v_mfma_f32_16x16x32_bf16 v[20:23], a[100:103], a[160:163], v[20:23]
  ds_read_b128 a[180:183], v123 offset:4096
  v_mfma_f32_16x16x32_bf16 v[32:35], a[104:107], a[160:163], v[32:35]
  buffer_load_dwordx4 v105, s[32:35], s64 offen offset:1024  lds
  ds_read_b64_tr_b16 a[128:129], v114 offset:8192
  v_mfma_f32_16x16x32_bf16 v[44:47], a[108:111], a[160:163], v[44:47]
  ds_read_b64_tr_b16 a[130:131], v114 offset:9216
  ds_read_b64_tr_b16 a[132:133], v115 offset:8192
  v_mfma_f32_16x16x32_bf16 v[56:59], a[112:115], a[160:163], v[56:59]
  ds_read_b64_tr_b16 a[134:135], v115 offset:9216
  ds_read_b64_tr_b16 a[136:137], v116 offset:8192
  v_mfma_f32_16x16x32_bf16 v[68:71], a[116:119], a[160:163], v[68:71]
  ds_read_b64_tr_b16 a[138:139], v116 offset:9216
  v_mfma_f32_16x16x32_bf16 v[80:83], a[120:123], a[160:163], v[80:83]
  buffer_load_dwordx4 v106, s[32:35], s64 offen offset:2048  lds
  ds_read_b64_tr_b16 a[140:141], v117 offset:8192
  v_mfma_f32_16x16x32_bf16 v[92:95], a[124:127], a[160:163], v[92:95]
  ds_read_b64_tr_b16 a[142:143], v117 offset:9216
  ds_read_b64_tr_b16 a[144:145], v118 offset:8192
  v_mfma_f32_16x16x32_bf16 v[12:15], a[96:99], a[164:167], v[12:15]
  ds_read_b64_tr_b16 a[146:147], v118 offset:9216
  ds_read_b64_tr_b16 a[148:149], v119 offset:8192
  v_mfma_f32_16x16x32_bf16 v[24:27], a[100:103], a[164:167], v[24:27]
  ds_read_b64_tr_b16 a[150:151], v119 offset:9216
  v_mfma_f32_16x16x32_bf16 v[36:39], a[104:107], a[164:167], v[36:39]
  buffer_load_dwordx4 v107, s[32:35], s64 offen offset:3072  lds
  ds_read_b64_tr_b16 a[152:153], v120 offset:8192
  v_mfma_f32_16x16x32_bf16 v[48:51], a[108:111], a[164:167], v[48:51]
  ds_read_b64_tr_b16 a[154:155], v120 offset:9216
  ds_read_b64_tr_b16 a[156:157], v121 offset:8192
  v_mfma_f32_16x16x32_bf16 v[60:63], a[112:115], a[164:167], v[60:63]
  ds_read_b64_tr_b16 a[158:159], v121 offset:9216
  ds_read_b64 a[32:33], v127 offset:0
  v_mfma_f32_16x16x32_bf16 v[72:75], a[116:119], a[164:167], v[72:75]
  s_add_u32 m0, s68, 53248
  ds_read_b64 a[34:35], v127 offset:32
  v_mfma_f32_16x16x32_bf16 v[84:87], a[120:123], a[164:167], v[84:87]
  buffer_load_dwordx4 v108, s[32:35], s64 offen offset:0  lds
  ds_read_b64 a[36:37], v127 offset:64
  v_mfma_f32_16x16x32_bf16 v[96:99], a[124:127], a[164:167], v[96:99]
  ds_read_b64 a[38:39], v127 offset:96
  ds_read_b64 a[40:41], v127 offset:128
  v_mfma_f32_16x16x32_bf16 v[16:19], a[96:99], a[168:171], v[16:19]
  ds_read_b64 a[42:43], v127 offset:160
  ds_read_b64 a[44:45], v127 offset:192
  v_mfma_f32_16x16x32_bf16 v[28:31], a[100:103], a[168:171], v[28:31]
  ds_read_b64 a[46:47], v127 offset:224
  v_mfma_f32_16x16x32_bf16 v[40:43], a[104:107], a[168:171], v[40:43]
  buffer_load_dwordx4 v109, s[32:35], s64 offen offset:1024  lds
  s_bfe_u32 s4, s75, 0x40010
  v_mfma_f32_16x16x32_bf16 v[52:55], a[108:111], a[168:171], v[52:55]
  s_lshl_b32 s5, s4, 7
  s_add_u32 s64, s78, s5
  v_mfma_f32_16x16x32_bf16 v[64:67], a[112:115], a[168:171], v[64:67]
  s_lshl_b32 s4, s4, 19
  s_add_u32 s65, s79, s4
  v_mfma_f32_16x16x32_bf16 v[76:79], a[116:119], a[168:171], v[76:79]
  v_mfma_f32_16x16x32_bf16 v[88:91], a[120:123], a[168:171], v[88:91]
  v_mfma_f32_16x16x32_bf16 v[100:103], a[124:127], a[168:171], v[100:103]
  s_waitcnt vmcnt(14) lgkmcnt(0)
  s_barrier
  v_mfma_f32_16x16x32_bf16 v[8:11], a[128:131], a[172:175], v[8:11]
  ds_read_b128 a[160:163], v122 offset:24576
  ds_read_b128 a[164:167], v122 offset:26624
  v_mfma_f32_16x16x32_bf16 v[20:23], a[132:135], a[172:175], v[20:23]
  s_add_u32 m0, s69, 0
  ds_read_b128 a[168:171], v122 offset:28672
  v_mfma_f32_16x16x32_bf16 v[32:35], a[136:139], a[172:175], v[32:35]
  buffer_load_dwordx4 v110, s[36:39], s65 offen offset:0  lds
  ds_read_b64_tr_b16 a[96:97], v114 offset:16384
  v_mfma_f32_16x16x32_bf16 v[44:47], a[140:143], a[172:175], v[44:47]
  ds_read_b64_tr_b16 a[98:99], v114 offset:17408
  ds_read_b64_tr_b16 a[100:101], v115 offset:16384
  v_mfma_f32_16x16x32_bf16 v[56:59], a[144:147], a[172:175], v[56:59]
  ds_read_b64_tr_b16 a[102:103], v115 offset:17408
  ds_read_b64_tr_b16 a[104:105], v116 offset:16384
  v_mfma_f32_16x16x32_bf16 v[68:71], a[148:151], a[172:175], v[68:71]
  ds_read_b64_tr_b16 a[106:107], v116 offset:17408
  v_mfma_f32_16x16x32_bf16 v[80:83], a[152:155], a[172:175], v[80:83]
  buffer_load_dwordx4 v111, s[36:39], s65 offen offset:1024  lds
  ds_read_b64_tr_b16 a[108:109], v117 offset:16384
  v_mfma_f32_16x16x32_bf16 v[92:95], a[156:159], a[172:175], v[92:95]
  ds_read_b64_tr_b16 a[110:111], v117 offset:17408
  ds_read_b64_tr_b16 a[112:113], v118 offset:16384
  v_mfma_f32_16x16x32_bf16 v[12:15], a[128:131], a[176:179], v[12:15]
  ds_read_b64_tr_b16 a[114:115], v118 offset:17408
  ds_read_b64_tr_b16 a[116:117], v119 offset:16384
  v_mfma_f32_16x16x32_bf16 v[24:27], a[132:135], a[176:179], v[24:27]
  ds_read_b64_tr_b16 a[118:119], v119 offset:17408
  v_mfma_f32_16x16x32_bf16 v[36:39], a[136:139], a[176:179], v[36:39]
  buffer_load_dwordx4 v112, s[36:39], s65 offen offset:2048  lds
  ds_read_b64_tr_b16 a[120:121], v120 offset:16384
  v_mfma_f32_16x16x32_bf16 v[48:51], a[140:143], a[176:179], v[48:51]
  ds_read_b64_tr_b16 a[122:123], v120 offset:17408
  ds_read_b64_tr_b16 a[124:125], v121 offset:16384
  v_mfma_f32_16x16x32_bf16 v[60:63], a[144:147], a[176:179], v[60:63]
  ds_read_b64_tr_b16 a[126:127], v121 offset:17408
  v_mfma_f32_16x16x32_bf16 v[72:75], a[148:151], a[176:179], v[72:75]
  v_mfma_f32_16x16x32_bf16 v[84:87], a[152:155], a[176:179], v[84:87]
  buffer_load_dwordx4 v113, s[36:39], s65 offen offset:3072  lds
  v_mfma_f32_16x16x32_bf16 v[96:99], a[156:159], a[176:179], v[96:99]
  v_mfma_f32_16x16x32_bf16 v[16:19], a[128:131], a[180:183], v[16:19]
  v_mfma_f32_16x16x32_bf16 v[28:31], a[132:135], a[180:183], v[28:31]
  s_add_u32 m0, s68, 0
  v_mfma_f32_16x16x32_bf16 v[40:43], a[136:139], a[180:183], v[40:43]
  buffer_load_dwordx4 v104, s[32:35], s64 offen offset:0  lds
  v_mfma_f32_16x16x32_bf16 v[52:55], a[140:143], a[180:183], v[52:55]
  v_mfma_f32_16x16x32_bf16 v[64:67], a[144:147], a[180:183], v[64:67]
  v_mfma_f32_16x16x32_bf16 v[76:79], a[148:151], a[180:183], v[76:79]
  v_mfma_f32_16x16x32_bf16 v[88:91], a[152:155], a[180:183], v[88:91]
  v_mfma_f32_16x16x32_bf16 v[100:103], a[156:159], a[180:183], v[100:103]
  s_waitcnt lgkmcnt(0)
  v_mfma_f32_16x16x32_bf16 v[8:11], a[96:99], a[160:163], v[8:11]
  ds_read_b128 a[172:175], v123 offset:24576
  ds_read_b128 a[176:179], v123 offset:26624
  v_mfma_f32_16x16x32_bf16 v[20:23], a[100:103], a[160:163], v[20:23]
  ds_read_b128 a[180:183], v123 offset:28672
  v_mfma_f32_16x16x32_bf16 v[32:35], a[104:107], a[160:163], v[32:35]
  buffer_load_dwordx4 v105, s[32:35], s64 offen offset:1024  lds
  ds_read_b64_tr_b16 a[128:129], v114 offset:24576
  v_mfma_f32_16x16x32_bf16 v[44:47], a[108:111], a[160:163], v[44:47]
  ds_read_b64_tr_b16 a[130:131], v114 offset:25600
  ds_read_b64_tr_b16 a[132:133], v115 offset:24576
  v_mfma_f32_16x16x32_bf16 v[56:59], a[112:115], a[160:163], v[56:59]
  buffer_load_dwordx4 v106, s[32:35], s64 offen offset:2048  lds
  ds_read_b64_tr_b16 a[134:135], v115 offset:25600
  v_mfma_f32_16x16x32_bf16 v[68:71], a[116:119], a[160:163], v[68:71]
  ds_read_b64_tr_b16 a[136:137], v116 offset:24576
  ds_read_b64_tr_b16 a[138:139], v116 offset:25600
  v_mfma_f32_16x16x32_bf16 v[80:83], a[120:123], a[160:163], v[80:83]
  buffer_load_dwordx4 v107, s[32:35], s64 offen offset:3072  lds
  ds_read_b64_tr_b16 a[140:141], v117 offset:24576
  v_mfma_f32_16x16x32_bf16 v[92:95], a[124:127], a[160:163], v[92:95]
  ds_read_b64_tr_b16 a[142:143], v117 offset:25600
  ds_read_b64_tr_b16 a[144:145], v118 offset:24576
  v_mfma_f32_16x16x32_bf16 v[12:15], a[96:99], a[164:167], v[12:15]
  s_add_u32 m0, s68, 4096
  ds_read_b64_tr_b16 a[146:147], v118 offset:25600
  v_mfma_f32_16x16x32_bf16 v[24:27], a[100:103], a[164:167], v[24:27]
  buffer_load_dwordx4 v108, s[32:35], s64 offen offset:0  lds
  ds_read_b64_tr_b16 a[148:149], v119 offset:24576
  v_mfma_f32_16x16x32_bf16 v[36:39], a[104:107], a[164:167], v[36:39]
  ds_read_b64_tr_b16 a[150:151], v119 offset:25600
  ds_read_b64_tr_b16 a[152:153], v120 offset:24576
  v_mfma_f32_16x16x32_bf16 v[48:51], a[108:111], a[164:167], v[48:51]
  buffer_load_dwordx4 v109, s[32:35], s64 offen offset:1024  lds
  ds_read_b64_tr_b16 a[154:155], v120 offset:25600
  v_mfma_f32_16x16x32_bf16 v[60:63], a[112:115], a[164:167], v[60:63]
  s_bfe_u32 s4, s75, 0x40014
  s_lshl_b32 s5, s4, 7
  v_mfma_f32_16x16x32_bf16 v[72:75], a[116:119], a[164:167], v[72:75]
  s_add_u32 s64, s78, s5
  s_lshl_b32 s4, s4, 19
  v_mfma_f32_16x16x32_bf16 v[84:87], a[120:123], a[164:167], v[84:87]
  s_add_u32 s65, s79, s4
  buffer_load_dwordx4 a[64:67], v124, s[44:47], s71 offen offset:0 nt
  v_mfma_f32_16x16x32_bf16 v[96:99], a[124:127], a[164:167], v[96:99]
  ds_read_b64_tr_b16 a[156:157], v121 offset:24576
  ds_read_b64_tr_b16 a[158:159], v121 offset:25600
  v_mfma_f32_16x16x32_bf16 v[16:19], a[96:99], a[168:171], v[16:19]
  buffer_load_dwordx4 a[68:71], v124, s[44:47], s71 offen offset:1024 nt
  v_mfma_f32_16x16x32_bf16 v[28:31], a[100:103], a[168:171], v[28:31]
  v_mfma_f32_16x16x32_bf16 v[40:43], a[104:107], a[168:171], v[40:43]
  buffer_load_dwordx4 a[72:75], v124, s[44:47], s71 offen offset:2048 nt
  v_mfma_f32_16x16x32_bf16 v[52:55], a[108:111], a[168:171], v[52:55]
  v_mfma_f32_16x16x32_bf16 v[64:67], a[112:115], a[168:171], v[64:67]
  buffer_load_dwordx4 a[76:79], v124, s[44:47], s71 offen offset:3072 nt
  v_mfma_f32_16x16x32_bf16 v[76:79], a[116:119], a[168:171], v[76:79]
  v_mfma_f32_16x16x32_bf16 v[88:91], a[120:123], a[168:171], v[88:91]
  v_mfma_f32_16x16x32_bf16 v[100:103], a[124:127], a[168:171], v[100:103]
  s_waitcnt vmcnt(14) lgkmcnt(0)
  s_barrier
  v_mfma_f32_16x16x32_bf16 v[8:11], a[128:131], a[172:175], v[8:11]
  ds_read_b128 a[160:163], v122 offset:49152
  ds_read_b128 a[164:167], v122 offset:51200
  v_mfma_f32_16x16x32_bf16 v[20:23], a[132:135], a[172:175], v[20:23]
  s_add_u32 m0, s69, 16384
  ds_read_b128 a[168:171], v122 offset:53248
  v_mfma_f32_16x16x32_bf16 v[32:35], a[136:139], a[172:175], v[32:35]
  buffer_load_dwordx4 v110, s[36:39], s65 offen offset:0  lds
  ds_read_b64_tr_b16 a[96:97], v114 offset:32768
  v_mfma_f32_16x16x32_bf16 v[44:47], a[140:143], a[172:175], v[44:47]
  ds_read_b64_tr_b16 a[98:99], v114 offset:33792
  ds_read_b64_tr_b16 a[100:101], v115 offset:32768
  v_mfma_f32_16x16x32_bf16 v[56:59], a[144:147], a[172:175], v[56:59]
  ds_read_b64_tr_b16 a[102:103], v115 offset:33792
  ds_read_b64_tr_b16 a[104:105], v116 offset:32768
  v_mfma_f32_16x16x32_bf16 v[68:71], a[148:151], a[172:175], v[68:71]
  ds_read_b64_tr_b16 a[106:107], v116 offset:33792
  v_mfma_f32_16x16x32_bf16 v[80:83], a[152:155], a[172:175], v[80:83]
  buffer_load_dwordx4 v111, s[36:39], s65 offen offset:1024  lds
  ds_read_b64_tr_b16 a[108:109], v117 offset:32768
  v_mfma_f32_16x16x32_bf16 v[92:95], a[156:159], a[172:175], v[92:95]
  ds_read_b64_tr_b16 a[110:111], v117 offset:33792
  ds_read_b64_tr_b16 a[112:113], v118 offset:32768
  v_mfma_f32_16x16x32_bf16 v[12:15], a[128:131], a[176:179], v[12:15]
  ds_read_b64_tr_b16 a[114:115], v118 offset:33792
  ds_read_b64_tr_b16 a[116:117], v119 offset:32768
  v_mfma_f32_16x16x32_bf16 v[24:27], a[132:135], a[176:179], v[24:27]
  ds_read_b64_tr_b16 a[118:119], v119 offset:33792
  v_mfma_f32_16x16x32_bf16 v[36:39], a[136:139], a[176:179], v[36:39]
  buffer_load_dwordx4 v112, s[36:39], s65 offen offset:2048  lds
  ds_read_b64_tr_b16 a[120:121], v120 offset:32768
  v_mfma_f32_16x16x32_bf16 v[48:51], a[140:143], a[176:179], v[48:51]
  ds_read_b64_tr_b16 a[122:123], v120 offset:33792
  ds_read_b64_tr_b16 a[124:125], v121 offset:32768
  v_mfma_f32_16x16x32_bf16 v[60:63], a[144:147], a[176:179], v[60:63]
  ds_read_b64_tr_b16 a[126:127], v121 offset:33792
  ds_write_b128 v126, a[48:51] offset:0
  v_mfma_f32_16x16x32_bf16 v[72:75], a[148:151], a[176:179], v[72:75]
  ds_write_b128 v126, a[52:55] offset:1152
  ds_write_b128 v126, a[56:59] offset:2304
  v_mfma_f32_16x16x32_bf16 v[84:87], a[152:155], a[176:179], v[84:87]
  buffer_load_dwordx4 v113, s[36:39], s65 offen offset:3072  lds
  ds_write_b128 v126, a[60:63] offset:3456
  v_mfma_f32_16x16x32_bf16 v[96:99], a[156:159], a[176:179], v[96:99]
  v_mfma_f32_16x16x32_bf16 v[16:19], a[128:131], a[180:183], v[16:19]
  v_mfma_f32_16x16x32_bf16 v[28:31], a[132:135], a[180:183], v[28:31]
  s_add_u32 m0, s68, 24576
  v_mfma_f32_16x16x32_bf16 v[40:43], a[136:139], a[180:183], v[40:43]
  buffer_load_dwordx4 v104, s[32:35], s64 offen offset:0  lds
  v_mfma_f32_16x16x32_bf16 v[52:55], a[140:143], a[180:183], v[52:55]
  v_mfma_f32_16x16x32_bf16 v[64:67], a[144:147], a[180:183], v[64:67]
  v_mfma_f32_16x16x32_bf16 v[76:79], a[148:151], a[180:183], v[76:79]
  v_mfma_f32_16x16x32_bf16 v[88:91], a[152:155], a[180:183], v[88:91]
  v_mfma_f32_16x16x32_bf16 v[100:103], a[156:159], a[180:183], v[100:103]
  s_waitcnt lgkmcnt(0)
  v_mfma_f32_16x16x32_bf16 v[8:11], a[96:99], a[160:163], v[8:11]
  ds_read_b128 a[172:175], v123 offset:49152
  ds_read_b128 a[176:179], v123 offset:51200
  v_mfma_f32_16x16x32_bf16 v[20:23], a[100:103], a[160:163], v[20:23]
  ds_read_b128 a[180:183], v123 offset:53248
  v_mfma_f32_16x16x32_bf16 v[32:35], a[104:107], a[160:163], v[32:35]
  buffer_load_dwordx4 v105, s[32:35], s64 offen offset:1024  lds
  ds_read_b64_tr_b16 a[128:129], v114 offset:40960
  v_mfma_f32_16x16x32_bf16 v[44:47], a[108:111], a[160:163], v[44:47]
  ds_read_b64_tr_b16 a[130:131], v114 offset:41984
  ds_read_b64_tr_b16 a[132:133], v115 offset:40960
  v_mfma_f32_16x16x32_bf16 v[56:59], a[112:115], a[160:163], v[56:59]
  ds_read_b64_tr_b16 a[134:135], v115 offset:41984
  ds_read_b64_tr_b16 a[136:137], v116 offset:40960
  v_mfma_f32_16x16x32_bf16 v[68:71], a[116:119], a[160:163], v[68:71]
  ds_read_b64_tr_b16 a[138:139], v116 offset:41984
  v_mfma_f32_16x16x32_bf16 v[80:83], a[120:123], a[160:163], v[80:83]
  buffer_load_dwordx4 v106, s[32:35], s64 offen offset:2048  lds
  ds_read_b64_tr_b16 a[140:141], v117 offset:40960
  v_mfma_f32_16x16x32_bf16 v[92:95], a[124:127], a[160:163], v[92:95]
  ds_read_b64_tr_b16 a[142:143], v117 offset:41984
  ds_read_b64_tr_b16 a[144:145], v118 offset:40960
  v_mfma_f32_16x16x32_bf16 v[12:15], a[96:99], a[164:167], v[12:15]
  ds_read_b64_tr_b16 a[146:147], v118 offset:41984
  ds_read_b64_tr_b16 a[148:149], v119 offset:40960
  v_mfma_f32_16x16x32_bf16 v[24:27], a[100:103], a[164:167], v[24:27]
  ds_read_b64_tr_b16 a[150:151], v119 offset:41984
  v_mfma_f32_16x16x32_bf16 v[36:39], a[104:107], a[164:167], v[36:39]
  buffer_load_dwordx4 v107, s[32:35], s64 offen offset:3072  lds
  ds_read_b64_tr_b16 a[152:153], v120 offset:40960
  v_mfma_f32_16x16x32_bf16 v[48:51], a[108:111], a[164:167], v[48:51]
  ds_read_b64_tr_b16 a[154:155], v120 offset:41984
  ds_read_b64_tr_b16 a[156:157], v121 offset:40960
  v_mfma_f32_16x16x32_bf16 v[60:63], a[112:115], a[164:167], v[60:63]
  ds_read_b64_tr_b16 a[158:159], v121 offset:41984
  ds_read_b64_tr_b16 a[184:185], v128 offset:0
  v_mfma_f32_16x16x32_bf16 v[72:75], a[116:119], a[164:167], v[72:75]
  s_add_u32 m0, s68, 28672
  ds_read_b64_tr_b16 a[190:191], v128 offset:32
  v_mfma_f32_16x16x32_bf16 v[84:87], a[120:123], a[164:167], v[84:87]
  buffer_load_dwordx4 v108, s[32:35], s64 offen offset:0  lds
  ds_read_b64_tr_b16 a[196:197], v128 offset:64
  v_mfma_f32_16x16x32_bf16 v[96:99], a[124:127], a[164:167], v[96:99]
  ds_read_b64_tr_b16 a[202:203], v128 offset:96
  ds_read_b64_tr_b16 a[208:209], v128 offset:128
  v_mfma_f32_16x16x32_bf16 v[16:19], a[96:99], a[168:171], v[16:19]
  ds_read_b64_tr_b16 a[214:215], v128 offset:160
  ds_read_b64_tr_b16 a[220:221], v128 offset:192
  v_mfma_f32_16x16x32_bf16 v[28:31], a[100:103], a[168:171], v[28:31]
  ds_read_b64_tr_b16 a[226:227], v128 offset:224
  v_mfma_f32_16x16x32_bf16 v[40:43], a[104:107], a[168:171], v[40:43]
  buffer_load_dwordx4 v109, s[32:35], s64 offen offset:1024  lds
  s_bfe_u32 s4, s75, 0x40018
  v_mfma_f32_16x16x32_bf16 v[52:55], a[108:111], a[168:171], v[52:55]
  s_lshl_b32 s5, s4, 7
  s_add_u32 s64, s78, s5
  v_mfma_f32_16x16x32_bf16 v[64:67], a[112:115], a[168:171], v[64:67]
  s_lshl_b32 s4, s4, 19
  s_add_u32 s65, s79, s4
  v_mfma_f32_16x16x32_bf16 v[76:79], a[116:119], a[168:171], v[76:79]
  v_mfma_f32_16x16x32_bf16 v[88:91], a[120:123], a[168:171], v[88:91]
  v_mfma_f32_16x16x32_bf16 v[100:103], a[124:127], a[168:171], v[100:103]
  s_waitcnt vmcnt(14) lgkmcnt(0)
  s_barrier
  v_mfma_f32_16x16x32_bf16 v[8:11], a[128:131], a[172:175], v[8:11]
  ds_read_b128 a[160:163], v122 offset:0
  ds_read_b128 a[164:167], v122 offset:2048
  v_mfma_f32_16x16x32_bf16 v[20:23], a[132:135], a[172:175], v[20:23]
  s_add_u32 m0, s69, 32768
  ds_read_b128 a[168:171], v122 offset:4096
  v_mfma_f32_16x16x32_bf16 v[32:35], a[136:139], a[172:175], v[32:35]
  buffer_load_dwordx4 v110, s[36:39], s65 offen offset:0  lds
  ds_read_b64_tr_b16 a[96:97], v114 offset:0
  v_mfma_f32_16x16x32_bf16 v[44:47], a[140:143], a[172:175], v[44:47]
  ds_read_b64_tr_b16 a[98:99], v114 offset:1024
  ds_read_b64_tr_b16 a[100:101], v115 offset:0
  v_mfma_f32_16x16x32_bf16 v[56:59], a[144:147], a[172:175], v[56:59]
  ds_read_b64_tr_b16 a[102:103], v115 offset:1024
  ds_read_b64_tr_b16 a[104:105], v116 offset:0
  v_mfma_f32_16x16x32_bf16 v[68:71], a[148:151], a[172:175], v[68:71]
  ds_read_b64_tr_b16 a[106:107], v116 offset:1024
  v_mfma_f32_16x16x32_bf16 v[80:83], a[152:155], a[172:175], v[80:83]
  buffer_load_dwordx4 v111, s[36:39], s65 offen offset:1024  lds
  ds_read_b64_tr_b16 a[108:109], v117 offset:0
  v_mfma_f32_16x16x32_bf16 v[92:95], a[156:159], a[172:175], v[92:95]
  ds_read_b64_tr_b16 a[110:111], v117 offset:1024
  ds_read_b64_tr_b16 a[112:113], v118 offset:0
  v_mfma_f32_16x16x32_bf16 v[12:15], a[128:131], a[176:179], v[12:15]
  ds_read_b64_tr_b16 a[114:115], v118 offset:1024
  ds_read_b64_tr_b16 a[116:117], v119 offset:0
  v_mfma_f32_16x16x32_bf16 v[24:27], a[132:135], a[176:179], v[24:27]
  ds_read_b64_tr_b16 a[118:119], v119 offset:1024
  v_mfma_f32_16x16x32_bf16 v[36:39], a[136:139], a[176:179], v[36:39]
  buffer_load_dwordx4 v112, s[36:39], s65 offen offset:2048  lds
  ds_read_b64_tr_b16 a[120:121], v120 offset:0
  v_mfma_f32_16x16x32_bf16 v[48:51], a[140:143], a[176:179], v[48:51]
  ds_read_b64_tr_b16 a[122:123], v120 offset:1024
  ds_read_b64_tr_b16 a[124:125], v121 offset:0
  v_mfma_f32_16x16x32_bf16 v[60:63], a[144:147], a[176:179], v[60:63]
  ds_read_b64_tr_b16 a[126:127], v121 offset:1024
  v_mfma_f32_16x16x32_bf16 v[72:75], a[148:151], a[176:179], v[72:75]
  v_mfma_f32_16x16x32_bf16 v[84:87], a[152:155], a[176:179], v[84:87]
  buffer_load_dwordx4 v113, s[36:39], s65 offen offset:3072  lds
  v_mfma_f32_16x16x32_bf16 v[96:99], a[156:159], a[176:179], v[96:99]
  v_mfma_f32_16x16x32_bf16 v[16:19], a[128:131], a[180:183], v[16:19]
  v_mfma_f32_16x16x32_bf16 v[28:31], a[132:135], a[180:183], v[28:31]
  s_add_u32 m0, s68, 49152
  v_mfma_f32_16x16x32_bf16 v[40:43], a[136:139], a[180:183], v[40:43]
  buffer_load_dwordx4 v104, s[32:35], s64 offen offset:0  lds
  v_mfma_f32_16x16x32_bf16 v[52:55], a[140:143], a[180:183], v[52:55]
  v_mfma_f32_16x16x32_bf16 v[64:67], a[144:147], a[180:183], v[64:67]
  v_mfma_f32_16x16x32_bf16 v[76:79], a[148:151], a[180:183], v[76:79]
  v_mfma_f32_16x16x32_bf16 v[88:91], a[152:155], a[180:183], v[88:91]
  v_mfma_f32_16x16x32_bf16 v[100:103], a[156:159], a[180:183], v[100:103]
  s_waitcnt lgkmcnt(0)
  v_mfma_f32_16x16x32_bf16 v[8:11], a[96:99], a[160:163], v[8:11]
  ds_read_b128 a[172:175], v123 offset:0
  ds_read_b128 a[176:179], v123 offset:2048
  v_mfma_f32_16x16x32_bf16 v[20:23], a[100:103], a[160:163], v[20:23]
  ds_read_b128 a[180:183], v123 offset:4096
  v_mfma_f32_16x16x32_bf16 v[32:35], a[104:107], a[160:163], v[32:35]
  buffer_load_dwordx4 v105, s[32:35], s64 offen offset:1024  lds
  ds_read_b64_tr_b16 a[128:129], v114 offset:8192
  v_mfma_f32_16x16x32_bf16 v[44:47], a[108:111], a[160:163], v[44:47]
  ds_read_b64_tr_b16 a[130:131], v114 offset:9216
  ds_read_b64_tr_b16 a[132:133], v115 offset:8192
  v_mfma_f32_16x16x32_bf16 v[56:59], a[112:115], a[160:163], v[56:59]
  buffer_load_dwordx4 v106, s[32:35], s64 offen offset:2048  lds
  ds_read_b64_tr_b16 a[134:135], v115 offset:9216
  v_mfma_f32_16x16x32_bf16 v[68:71], a[116:119], a[160:163], v[68:71]
  ds_read_b64_tr_b16 a[136:137], v116 offset:8192
  ds_read_b64_tr_b16 a[138:139], v116 offset:9216
  v_mfma_f32_16x16x32_bf16 v[80:83], a[120:123], a[160:163], v[80:83]
  buffer_load_dwordx4 v107, s[32:35], s64 offen offset:3072  lds
  ds_read_b64_tr_b16 a[140:141], v117 offset:8192
  v_mfma_f32_16x16x32_bf16 v[92:95], a[124:127], a[160:163], v[92:95]
  ds_read_b64_tr_b16 a[142:143], v117 offset:9216
  ds_read_b64_tr_b16 a[144:145], v118 offset:8192
  v_mfma_f32_16x16x32_bf16 v[12:15], a[96:99], a[164:167], v[12:15]
  s_add_u32 m0, s68, 53248
  ds_read_b64_tr_b16 a[146:147], v118 offset:9216
  v_mfma_f32_16x16x32_bf16 v[24:27], a[100:103], a[164:167], v[24:27]
  buffer_load_dwordx4 v108, s[32:35], s64 offen offset:0  lds
  ds_read_b64_tr_b16 a[148:149], v119 offset:8192
  v_mfma_f32_16x16x32_bf16 v[36:39], a[104:107], a[164:167], v[36:39]
  ds_read_b64_tr_b16 a[150:151], v119 offset:9216
  ds_read_b64_tr_b16 a[152:153], v120 offset:8192
  v_mfma_f32_16x16x32_bf16 v[48:51], a[108:111], a[164:167], v[48:51]
  buffer_load_dwordx4 v109, s[32:35], s64 offen offset:1024  lds
  ds_read_b64_tr_b16 a[154:155], v120 offset:9216
  v_mfma_f32_16x16x32_bf16 v[60:63], a[112:115], a[164:167], v[60:63]
  s_bfe_u32 s4, s75, 0x4001c
  s_lshl_b32 s5, s4, 7
  v_mfma_f32_16x16x32_bf16 v[72:75], a[116:119], a[164:167], v[72:75]
  s_add_u32 s64, s78, s5
  s_lshl_b32 s4, s4, 19
  v_mfma_f32_16x16x32_bf16 v[84:87], a[120:123], a[164:167], v[84:87]
  s_add_u32 s65, s79, s4
  buffer_load_dwordx4 a[80:83], v124, s[44:47], s72 offen offset:0 nt
  v_mfma_f32_16x16x32_bf16 v[96:99], a[124:127], a[164:167], v[96:99]
  ds_read_b64_tr_b16 a[156:157], v121 offset:8192
  ds_read_b64_tr_b16 a[158:159], v121 offset:9216
  v_mfma_f32_16x16x32_bf16 v[16:19], a[96:99], a[168:171], v[16:19]
  buffer_load_dwordx4 a[84:87], v124, s[44:47], s72 offen offset:1024 nt
  s_lshl_b32 s12, s26, 3
  v_mfma_f32_16x16x32_bf16 v[28:31], a[100:103], a[168:171], v[28:31]
  s_add_u32 s12, s12, s18
  s_mul_i32 s12, s12, 786432
  v_mfma_f32_16x16x32_bf16 v[40:43], a[104:107], a[168:171], v[40:43]
  buffer_load_dwordx4 a[88:91], v124, s[44:47], s72 offen offset:2048 nt
  s_mul_i32 s13, s3, 196608
  v_mfma_f32_16x16x32_bf16 v[52:55], a[108:111], a[168:171], v[52:55]
  s_add_u32 s8, s12, s13
  s_lshl_b32 s9, s3, 21
  v_mfma_f32_16x16x32_bf16 v[64:67], a[112:115], a[168:171], v[64:67]
  buffer_load_dwordx4 a[92:95], v124, s[44:47], s72 offen offset:3072 nt
  s_lshl_b32 s12, s19, 7
  v_mfma_f32_16x16x32_bf16 v[76:79], a[116:119], a[168:171], v[76:79]
  s_add_u32 s9, s9, s12
  s_and_b32 s12, s31, 7
  v_mfma_f32_16x16x32_bf16 v[88:91], a[120:123], a[168:171], v[88:91]
  s_lshr_b32 s13, s31, 3
  s_mul_i32 s12, s12, 1
  v_mfma_f32_16x16x32_bf16 v[100:103], a[124:127], a[168:171], v[100:103]
  s_waitcnt vmcnt(14) lgkmcnt(0)
  s_barrier
  v_mfma_f32_16x16x32_bf16 v[8:11], a[128:131], a[172:175], v[8:11]
  ds_read_b128 a[160:163], v122 offset:24576
  ds_read_b128 a[164:167], v122 offset:26624
  v_mfma_f32_16x16x32_bf16 v[20:23], a[132:135], a[172:175], v[20:23]
  s_add_u32 m0, s69, 0
  ds_read_b128 a[168:171], v122 offset:28672
  v_mfma_f32_16x16x32_bf16 v[32:35], a[136:139], a[172:175], v[32:35]
  buffer_load_dwordx4 v110, s[36:39], s65 offen offset:0  lds
  ds_read_b64_tr_b16 a[96:97], v114 offset:16384
  v_mfma_f32_16x16x32_bf16 v[44:47], a[140:143], a[172:175], v[44:47]
  ds_read_b64_tr_b16 a[98:99], v114 offset:17408
  ds_read_b64_tr_b16 a[100:101], v115 offset:16384
  v_mfma_f32_16x16x32_bf16 v[56:59], a[144:147], a[172:175], v[56:59]
  ds_read_b64_tr_b16 a[102:103], v115 offset:17408
  ds_read_b64_tr_b16 a[104:105], v116 offset:16384
  v_mfma_f32_16x16x32_bf16 v[68:71], a[148:151], a[172:175], v[68:71]
  ds_read_b64_tr_b16 a[106:107], v116 offset:17408
  v_mfma_f32_16x16x32_bf16 v[80:83], a[152:155], a[172:175], v[80:83]
  buffer_load_dwordx4 v111, s[36:39], s65 offen offset:1024  lds
  ds_read_b64_tr_b16 a[108:109], v117 offset:16384
  v_mfma_f32_16x16x32_bf16 v[92:95], a[156:159], a[172:175], v[92:95]
  ds_read_b64_tr_b16 a[110:111], v117 offset:17408
  ds_read_b64_tr_b16 a[112:113], v118 offset:16384
  v_mfma_f32_16x16x32_bf16 v[12:15], a[128:131], a[176:179], v[12:15]
  ds_read_b64_tr_b16 a[114:115], v118 offset:17408
  ds_read_b64_tr_b16 a[116:117], v119 offset:16384
  v_mfma_f32_16x16x32_bf16 v[24:27], a[132:135], a[176:179], v[24:27]
  ds_read_b64_tr_b16 a[118:119], v119 offset:17408
  v_mfma_f32_16x16x32_bf16 v[36:39], a[136:139], a[176:179], v[36:39]
  buffer_load_dwordx4 v112, s[36:39], s65 offen offset:2048  lds
  ds_read_b64_tr_b16 a[120:121], v120 offset:16384
  v_mfma_f32_16x16x32_bf16 v[48:51], a[140:143], a[176:179], v[48:51]
  ds_read_b64_tr_b16 a[122:123], v120 offset:17408
  ds_read_b64_tr_b16 a[124:125], v121 offset:16384
  v_mfma_f32_16x16x32_bf16 v[60:63], a[144:147], a[176:179], v[60:63]
  ds_read_b64_tr_b16 a[126:127], v121 offset:17408
  ds_write_b128 v126, a[64:67] offset:0
  v_mfma_f32_16x16x32_bf16 v[72:75], a[148:151], a[176:179], v[72:75]
  ds_write_b128 v126, a[68:71] offset:1152
  ds_write_b128 v126, a[72:75] offset:2304
  v_mfma_f32_16x16x32_bf16 v[84:87], a[152:155], a[176:179], v[84:87]
  buffer_load_dwordx4 v113, s[36:39], s65 offen offset:3072  lds
  ds_write_b128 v126, a[76:79] offset:3456
  v_mfma_f32_16x16x32_bf16 v[96:99], a[156:159], a[176:179], v[96:99]
  s_mul_i32 s13, s13, 0
  s_add_u32 s12, s12, s13
  v_mfma_f32_16x16x32_bf16 v[16:19], a[128:131], a[180:183], v[16:19]
  s_and_b32 s14, s12, 7
  s_lshl_b32 s12, s3, 12
  v_mfma_f32_16x16x32_bf16 v[28:31], a[132:135], a[180:183], v[28:31]
  s_add_u32 m0, s68, 0
  s_add_u32 s40, s12, 143360
  v_mfma_f32_16x16x32_bf16 v[40:43], a[136:139], a[180:183], v[40:43]
  buffer_load_dwordx4 v104, s[32:35], s64 offen offset:0  lds
  s_add_u32 s41, s12, 16384
  v_mfma_f32_16x16x32_bf16 v[52:55], a[140:143], a[180:183], v[52:55]
  s_add_u32 s42, s12, 73728
  s_add_u32 s43, s12, 32768
  v_mfma_f32_16x16x32_bf16 v[64:67], a[144:147], a[180:183], v[64:67]
  s_add_u32 s66, s12, 98304
  s_add_u32 s74, s12, 0
  v_mfma_f32_16x16x32_bf16 v[76:79], a[148:151], a[180:183], v[76:79]
  s_add_u32 s17, s12, 49152
  v_mfma_f32_16x16x32_bf16 v[88:91], a[152:155], a[180:183], v[88:91]
  v_mfma_f32_16x16x32_bf16 v[100:103], a[156:159], a[180:183], v[100:103]
  s_waitcnt lgkmcnt(0)
  v_mfma_f32_16x16x32_bf16 v[8:11], a[96:99], a[160:163], v[8:11]
  ds_read_b128 a[172:175], v123 offset:24576
  ds_read_b128 a[176:179], v123 offset:26624
  v_mfma_f32_16x16x32_bf16 v[20:23], a[100:103], a[160:163], v[20:23]
  ds_read_b128 a[180:183], v123 offset:28672
  v_mfma_f32_16x16x32_bf16 v[32:35], a[104:107], a[160:163], v[32:35]
  buffer_load_dwordx4 v105, s[32:35], s64 offen offset:1024  lds
  ds_read_b64_tr_b16 a[128:129], v114 offset:24576
  v_mfma_f32_16x16x32_bf16 v[44:47], a[108:111], a[160:163], v[44:47]
  ds_read_b64_tr_b16 a[130:131], v114 offset:25600
  ds_read_b64_tr_b16 a[132:133], v115 offset:24576
  v_mfma_f32_16x16x32_bf16 v[56:59], a[112:115], a[160:163], v[56:59]
  ds_read_b64_tr_b16 a[134:135], v115 offset:25600
  ds_read_b64_tr_b16 a[136:137], v116 offset:24576
  v_mfma_f32_16x16x32_bf16 v[68:71], a[116:119], a[160:163], v[68:71]
  ds_read_b64_tr_b16 a[138:139], v116 offset:25600
  v_mfma_f32_16x16x32_bf16 v[80:83], a[120:123], a[160:163], v[80:83]
  buffer_load_dwordx4 v106, s[32:35], s64 offen offset:2048  lds
  ds_read_b64_tr_b16 a[140:141], v117 offset:24576
  v_mfma_f32_16x16x32_bf16 v[92:95], a[124:127], a[160:163], v[92:95]
  ds_read_b64_tr_b16 a[142:143], v117 offset:25600
  ds_read_b64_tr_b16 a[144:145], v118 offset:24576
  v_mfma_f32_16x16x32_bf16 v[12:15], a[96:99], a[164:167], v[12:15]
  ds_read_b64_tr_b16 a[146:147], v118 offset:25600
  ds_read_b64_tr_b16 a[148:149], v119 offset:24576
  v_mfma_f32_16x16x32_bf16 v[24:27], a[100:103], a[164:167], v[24:27]
  ds_read_b64_tr_b16 a[150:151], v119 offset:25600
  v_mfma_f32_16x16x32_bf16 v[36:39], a[104:107], a[164:167], v[36:39]
  buffer_load_dwordx4 v107, s[32:35], s64 offen offset:3072  lds
  ds_read_b64_tr_b16 a[152:153], v120 offset:24576
  v_mfma_f32_16x16x32_bf16 v[48:51], a[108:111], a[164:167], v[48:51]
  ds_read_b64_tr_b16 a[154:155], v120 offset:25600
  ds_read_b64_tr_b16 a[156:157], v121 offset:24576
  v_mfma_f32_16x16x32_bf16 v[60:63], a[112:115], a[164:167], v[60:63]
  ds_read_b64_tr_b16 a[158:159], v121 offset:25600
  ds_read_b64_tr_b16 a[186:187], v128 offset:0
  v_mfma_f32_16x16x32_bf16 v[72:75], a[116:119], a[164:167], v[72:75]
  s_add_u32 m0, s68, 4096
  ds_read_b64_tr_b16 a[192:193], v128 offset:32
  v_mfma_f32_16x16x32_bf16 v[84:87], a[120:123], a[164:167], v[84:87]
  buffer_load_dwordx4 v108, s[32:35], s64 offen offset:0  lds
  ds_read_b64_tr_b16 a[198:199], v128 offset:64
  v_mfma_f32_16x16x32_bf16 v[96:99], a[124:127], a[164:167], v[96:99]
  ds_read_b64_tr_b16 a[204:205], v128 offset:96
  ds_read_b64_tr_b16 a[210:211], v128 offset:128
  v_mfma_f32_16x16x32_bf16 v[16:19], a[96:99], a[168:171], v[16:19]
  ds_read_b64_tr_b16 a[216:217], v128 offset:160
  ds_read_b64_tr_b16 a[222:223], v128 offset:192
  v_mfma_f32_16x16x32_bf16 v[28:31], a[100:103], a[168:171], v[28:31]
  ds_read_b64_tr_b16 a[228:229], v128 offset:224
  v_mfma_f32_16x16x32_bf16 v[40:43], a[104:107], a[168:171], v[40:43]
  buffer_load_dwordx4 v109, s[32:35], s64 offen offset:1024  lds
  v_mfma_f32_16x16x32_bf16 v[52:55], a[108:111], a[168:171], v[52:55]
  v_mfma_f32_16x16x32_bf16 v[64:67], a[112:115], a[168:171], v[64:67]
  v_mfma_f32_16x16x32_bf16 v[76:79], a[116:119], a[168:171], v[76:79]
  v_mfma_f32_16x16x32_bf16 v[88:91], a[120:123], a[168:171], v[88:91]
  v_mfma_f32_16x16x32_bf16 v[100:103], a[124:127], a[168:171], v[100:103]
  s_waitcnt vmcnt(14) lgkmcnt(0)
  s_barrier
  v_mfma_f32_16x16x32_bf16 v[8:11], a[128:131], a[172:175], v[8:11]
  ds_read_b128 a[160:163], v122 offset:49152
  ds_read_b128 a[164:167], v122 offset:51200
  v_mfma_f32_16x16x32_bf16 v[20:23], a[132:135], a[172:175], v[20:23]
  s_mov_b32 m0, s40
  s_add_u32 s15, s14, 0
  v_mfma_f32_16x16x32_bf16 v[32:35], a[136:139], a[172:175], v[32:35]
  s_and_b32 s15, s15, 7
  s_lshl_b32 s15, s15, 16
  v_mfma_f32_16x16x32_bf16 v[44:47], a[140:143], a[172:175], v[44:47]
  s_add_u32 s15, s15, s9
  buffer_load_dwordx4 v130, s[52:55], s15 offen offset:0  lds
  v_mfma_f32_16x16x32_bf16 v[56:59], a[144:147], a[172:175], v[56:59]
  buffer_load_dwordx4 v131, s[52:55], s15 offen offset:1024  lds
  ds_read_b128 a[168:171], v122 offset:53248
  v_mfma_f32_16x16x32_bf16 v[68:71], a[148:151], a[172:175], v[68:71]
  ds_read_b64_tr_b16 a[96:97], v114 offset:32768
  ds_read_b64_tr_b16 a[98:99], v114 offset:33792
  v_mfma_f32_16x16x32_bf16 v[80:83], a[152:155], a[172:175], v[80:83]
  ds_read_b64_tr_b16 a[100:101], v115 offset:32768
  ds_read_b64_tr_b16 a[102:103], v115 offset:33792
  v_mfma_f32_16x16x32_bf16 v[92:95], a[156:159], a[172:175], v[92:95]
  buffer_load_dwordx4 v132, s[52:55], s15 offen offset:2048  lds
  ds_read_b64_tr_b16 a[104:105], v116 offset:32768
  v_mfma_f32_16x16x32_bf16 v[12:15], a[128:131], a[176:179], v[12:15]
  ds_read_b64_tr_b16 a[106:107], v116 offset:33792
  ds_read_b64_tr_b16 a[108:109], v117 offset:32768
  v_mfma_f32_16x16x32_bf16 v[24:27], a[132:135], a[176:179], v[24:27]
  buffer_load_dwordx4 v133, s[52:55], s15 offen offset:3072  lds
  ds_read_b64_tr_b16 a[110:111], v117 offset:33792
  v_mfma_f32_16x16x32_bf16 v[36:39], a[136:139], a[176:179], v[36:39]
  ds_read_b64_tr_b16 a[112:113], v118 offset:32768
  ds_read_b64_tr_b16 a[114:115], v118 offset:33792
  v_mfma_f32_16x16x32_bf16 v[48:51], a[140:143], a[176:179], v[48:51]
  s_mov_b32 m0, s41
  s_add_u32 s15, s14, 1
  v_mfma_f32_16x16x32_bf16 v[60:63], a[144:147], a[176:179], v[60:63]
  s_and_b32 s15, s15, 7
  s_lshl_b32 s15, s15, 16
  v_mfma_f32_16x16x32_bf16 v[72:75], a[148:151], a[176:179], v[72:75]
  s_add_u32 s15, s15, s9
  buffer_load_dwordx4 v130, s[52:55], s15 offen offset:0  lds
  v_mfma_f32_16x16x32_bf16 v[84:87], a[152:155], a[176:179], v[84:87]
  ds_read_b64_tr_b16 a[116:117], v119 offset:32768
  ds_read_b64_tr_b16 a[118:119], v119 offset:33792
  v_mfma_f32_16x16x32_bf16 v[96:99], a[156:159], a[176:179], v[96:99]
  buffer_load_dwordx4 v131, s[52:55], s15 offen offset:1024  lds
  ds_read_b64_tr_b16 a[120:121], v120 offset:32768
  v_mfma_f32_16x16x32_bf16 v[16:19], a[128:131], a[180:183], v[16:19]
  ds_read_b64_tr_b16 a[122:123], v120 offset:33792
  ds_read_b64_tr_b16 a[124:125], v121 offset:32768
  v_mfma_f32_16x16x32_bf16 v[28:31], a[132:135], a[180:183], v[28:31]
  buffer_load_dwordx4 v132, s[52:55], s15 offen offset:2048  lds
  ds_read_b64_tr_b16 a[126:127], v121 offset:33792
  v_mfma_f32_16x16x32_bf16 v[40:43], a[136:139], a[180:183], v[40:43]
  v_mfma_f32_16x16x32_bf16 v[52:55], a[140:143], a[180:183], v[52:55]
  v_mfma_f32_16x16x32_bf16 v[64:67], a[144:147], a[180:183], v[64:67]
  buffer_load_dwordx4 v133, s[52:55], s15 offen offset:3072  lds
  v_mfma_f32_16x16x32_bf16 v[76:79], a[148:151], a[180:183], v[76:79]
  v_mfma_f32_16x16x32_bf16 v[88:91], a[152:155], a[180:183], v[88:91]
  v_mfma_f32_16x16x32_bf16 v[100:103], a[156:159], a[180:183], v[100:103]
  s_waitcnt lgkmcnt(0)
  v_mfma_f32_16x16x32_bf16 v[8:11], a[96:99], a[160:163], v[8:11]
  ds_read_b128 a[172:175], v123 offset:49152
  ds_read_b128 a[176:179], v123 offset:51200
  v_mfma_f32_16x16x32_bf16 v[20:23], a[100:103], a[160:163], v[20:23]
  s_mov_b32 m0, s42
  s_add_u32 s15, s14, 2
  v_mfma_f32_16x16x32_bf16 v[32:35], a[104:107], a[160:163], v[32:35]
  s_and_b32 s15, s15, 7
  s_lshl_b32 s15, s15, 16
  v_mfma_f32_16x16x32_bf16 v[44:47], a[108:111], a[160:163], v[44:47]
  s_add_u32 s15, s15, s9
  buffer_load_dwordx4 v130, s[52:55], s15 offen offset:0  lds
  v_mfma_f32_16x16x32_bf16 v[56:59], a[112:115], a[160:163], v[56:59]
  ds_read_b128 a[180:183], v123 offset:53248
  ds_read_b64_tr_b16 a[128:129], v114 offset:40960
  v_mfma_f32_16x16x32_bf16 v[68:71], a[116:119], a[160:163], v[68:71]
  ds_read_b64_tr_b16 a[130:131], v114 offset:41984
  ds_read_b64_tr_b16 a[132:133], v115 offset:40960
  v_mfma_f32_16x16x32_bf16 v[80:83], a[120:123], a[160:163], v[80:83]
  ds_read_b64_tr_b16 a[134:135], v115 offset:41984
  ds_read_b64_tr_b16 a[136:137], v116 offset:40960
  v_mfma_f32_16x16x32_bf16 v[92:95], a[124:127], a[160:163], v[92:95]
  buffer_load_dwordx4 v131, s[52:55], s15 offen offset:1024  lds
  ds_read_b64_tr_b16 a[138:139], v116 offset:41984
  v_mfma_f32_16x16x32_bf16 v[12:15], a[96:99], a[164:167], v[12:15]
  ds_read_b64_tr_b16 a[140:141], v117 offset:40960
  ds_read_b64_tr_b16 a[142:143], v117 offset:41984
  v_mfma_f32_16x16x32_bf16 v[24:27], a[100:103], a[164:167], v[24:27]
  ds_read_b64_tr_b16 a[144:145], v118 offset:40960
  ds_read_b64_tr_b16 a[146:147], v118 offset:41984
  v_mfma_f32_16x16x32_bf16 v[36:39], a[104:107], a[164:167], v[36:39]
  ds_read_b64_tr_b16 a[148:149], v119 offset:40960
  ds_read_b64_tr_b16 a[150:151], v119 offset:41984
  v_mfma_f32_16x16x32_bf16 v[48:51], a[108:111], a[164:167], v[48:51]
  ds_read_b64_tr_b16 a[152:153], v120 offset:40960
  ds_read_b64_tr_b16 a[154:155], v120 offset:41984
  v_mfma_f32_16x16x32_bf16 v[60:63], a[112:115], a[164:167], v[60:63]
  buffer_load_dwordx4 v132, s[52:55], s15 offen offset:2048  lds
  ds_read_b64_tr_b16 a[156:157], v121 offset:40960
  v_mfma_f32_16x16x32_bf16 v[72:75], a[116:119], a[164:167], v[72:75]
  ds_read_b64_tr_b16 a[158:159], v121 offset:41984
  v_mfma_f32_16x16x32_bf16 v[84:87], a[120:123], a[164:167], v[84:87]
  v_mfma_f32_16x16x32_bf16 v[96:99], a[124:127], a[164:167], v[96:99]
  v_mfma_f32_16x16x32_bf16 v[16:19], a[96:99], a[168:171], v[16:19]
  v_mfma_f32_16x16x32_bf16 v[28:31], a[100:103], a[168:171], v[28:31]
  buffer_load_dwordx4 v133, s[52:55], s15 offen offset:3072  lds
  v_mfma_f32_16x16x32_bf16 v[40:43], a[104:107], a[168:171], v[40:43]
  v_mfma_f32_16x16x32_bf16 v[52:55], a[108:111], a[168:171], v[52:55]
  v_mfma_f32_16x16x32_bf16 v[64:67], a[112:115], a[168:171], v[64:67]
  v_mfma_f32_16x16x32_bf16 v[76:79], a[116:119], a[168:171], v[76:79]
  v_mfma_f32_16x16x32_bf16 v[88:91], a[120:123], a[168:171], v[88:91]
  v_mfma_f32_16x16x32_bf16 v[100:103], a[124:127], a[168:171], v[100:103]
  s_waitcnt vmcnt(12) lgkmcnt(0)
  s_barrier
  v_mfma_f32_16x16x32_bf16 v[8:11], a[128:131], a[172:175], v[8:11]
  ds_read_b128 a[160:163], v122 offset:0
  ds_read_b128 a[164:167], v122 offset:2048
  v_mfma_f32_16x16x32_bf16 v[20:23], a[132:135], a[172:175], v[20:23]
  s_mov_b32 m0, s43
  s_add_u32 s15, s14, 3
  v_mfma_f32_16x16x32_bf16 v[32:35], a[136:139], a[172:175], v[32:35]
  s_and_b32 s15, s15, 7
  s_lshl_b32 s15, s15, 16
  v_mfma_f32_16x16x32_bf16 v[44:47], a[140:143], a[172:175], v[44:47]
  s_add_u32 s15, s15, s9
  buffer_load_dwordx4 v130, s[52:55], s15 offen offset:0  lds
  v_mfma_f32_16x16x32_bf16 v[56:59], a[144:147], a[172:175], v[56:59]
  ds_read_b128 a[168:171], v122 offset:4096
  ds_read_b64_tr_b16 a[96:97], v114 offset:0
  v_mfma_f32_16x16x32_bf16 v[68:71], a[148:151], a[172:175], v[68:71]
  ds_read_b64_tr_b16 a[98:99], v114 offset:1024
  ds_read_b64_tr_b16 a[100:101], v115 offset:0
  v_mfma_f32_16x16x32_bf16 v[80:83], a[152:155], a[172:175], v[80:83]
  ds_read_b64_tr_b16 a[102:103], v115 offset:1024
  ds_read_b64_tr_b16 a[104:105], v116 offset:0
  v_mfma_f32_16x16x32_bf16 v[92:95], a[156:159], a[172:175], v[92:95]
  buffer_load_dwordx4 v131, s[52:55], s15 offen offset:1024  lds
  ds_read_b64_tr_b16 a[106:107], v116 offset:1024
  v_mfma_f32_16x16x32_bf16 v[12:15], a[128:131], a[176:179], v[12:15]
  ds_read_b64_tr_b16 a[108:109], v117 offset:0
  ds_read_b64_tr_b16 a[110:111], v117 offset:1024
  v_mfma_f32_16x16x32_bf16 v[24:27], a[132:135], a[176:179], v[24:27]
  ds_read_b64_tr_b16 a[112:113], v118 offset:0
  ds_read_b64_tr_b16 a[114:115], v118 offset:1024
  v_mfma_f32_16x16x32_bf16 v[36:39], a[136:139], a[176:179], v[36:39]
  ds_read_b64_tr_b16 a[116:117], v119 offset:0
  ds_read_b64_tr_b16 a[118:119], v119 offset:1024
  v_mfma_f32_16x16x32_bf16 v[48:51], a[140:143], a[176:179], v[48:51]
  ds_read_b64_tr_b16 a[120:121], v120 offset:0
  ds_read_b64_tr_b16 a[122:123], v120 offset:1024
  v_mfma_f32_16x16x32_bf16 v[60:63], a[144:147], a[176:179], v[60:63]
  buffer_load_dwordx4 v132, s[52:55], s15 offen offset:2048  lds
  ds_read_b64_tr_b16 a[124:125], v121 offset:0
  v_mfma_f32_16x16x32_bf16 v[72:75], a[148:151], a[176:179], v[72:75]
  ds_read_b64_tr_b16 a[126:127], v121 offset:1024
  ds_write_b128 v126, a[80:83] offset:0
  v_mfma_f32_16x16x32_bf16 v[84:87], a[152:155], a[176:179], v[84:87]
  ds_write_b128 v126, a[84:87] offset:1152
  ds_write_b128 v126, a[88:91] offset:2304
  v_mfma_f32_16x16x32_bf16 v[96:99], a[156:159], a[176:179], v[96:99]
  ds_write_b128 v126, a[92:95] offset:3456
  v_mfma_f32_16x16x32_bf16 v[16:19], a[128:131], a[180:183], v[16:19]
  v_mfma_f32_16x16x32_bf16 v[28:31], a[132:135], a[180:183], v[28:31]
  buffer_load_dwordx4 v133, s[52:55], s15 offen offset:3072  lds
  v_mfma_f32_16x16x32_bf16 v[40:43], a[136:139], a[180:183], v[40:43]
  v_mfma_f32_16x16x32_bf16 v[52:55], a[140:143], a[180:183], v[52:55]
  v_mfma_f32_16x16x32_bf16 v[64:67], a[144:147], a[180:183], v[64:67]
  v_mfma_f32_16x16x32_bf16 v[76:79], a[148:151], a[180:183], v[76:79]
  v_mfma_f32_16x16x32_bf16 v[88:91], a[152:155], a[180:183], v[88:91]
  v_mfma_f32_16x16x32_bf16 v[100:103], a[156:159], a[180:183], v[100:103]
  s_waitcnt lgkmcnt(0)
  v_mfma_f32_16x16x32_bf16 v[8:11], a[96:99], a[160:163], v[8:11]
  ds_read_b128 a[172:175], v123 offset:0
  ds_read_b128 a[176:179], v123 offset:2048
  v_mfma_f32_16x16x32_bf16 v[20:23], a[100:103], a[160:163], v[20:23]
  s_mov_b32 m0, s66
  s_add_u32 s15, s14, 4
  v_mfma_f32_16x16x32_bf16 v[32:35], a[104:107], a[160:163], v[32:35]
  s_and_b32 s15, s15, 7
  s_lshl_b32 s15, s15, 16
  v_mfma_f32_16x16x32_bf16 v[44:47], a[108:111], a[160:163], v[44:47]
  s_add_u32 s15, s15, s9
  buffer_load_dwordx4 v130, s[52:55], s15 offen offset:0  lds
  v_mfma_f32_16x16x32_bf16 v[56:59], a[112:115], a[160:163], v[56:59]
  ds_read_b128 a[180:183], v123 offset:4096
  ds_read_b64_tr_b16 a[128:129], v114 offset:8192
  v_mfma_f32_16x16x32_bf16 v[68:71], a[116:119], a[160:163], v[68:71]
  ds_read_b64_tr_b16 a[130:131], v114 offset:9216
  ds_read_b64_tr_b16 a[132:133], v115 offset:8192
  v_mfma_f32_16x16x32_bf16 v[80:83], a[120:123], a[160:163], v[80:83]
  ds_read_b64_tr_b16 a[134:135], v115 offset:9216
  ds_read_b64_tr_b16 a[136:137], v116 offset:8192
  v_mfma_f32_16x16x32_bf16 v[92:95], a[124:127], a[160:163], v[92:95]
  buffer_load_dwordx4 v131, s[52:55], s15 offen offset:1024  lds
  ds_read_b64_tr_b16 a[138:139], v116 offset:9216
  v_mfma_f32_16x16x32_bf16 v[12:15], a[96:99], a[164:167], v[12:15]
  ds_read_b64_tr_b16 a[140:141], v117 offset:8192
  ds_read_b64_tr_b16 a[142:143], v117 offset:9216
  v_mfma_f32_16x16x32_bf16 v[24:27], a[100:103], a[164:167], v[24:27]
  ds_read_b64_tr_b16 a[144:145], v118 offset:8192
  ds_read_b64_tr_b16 a[146:147], v118 offset:9216
  v_mfma_f32_16x16x32_bf16 v[36:39], a[104:107], a[164:167], v[36:39]
  ds_read_b64_tr_b16 a[148:149], v119 offset:8192
  ds_read_b64_tr_b16 a[150:151], v119 offset:9216
  v_mfma_f32_16x16x32_bf16 v[48:51], a[108:111], a[164:167], v[48:51]
  ds_read_b64_tr_b16 a[152:153], v120 offset:8192
  ds_read_b64_tr_b16 a[154:155], v120 offset:9216
  v_mfma_f32_16x16x32_bf16 v[60:63], a[112:115], a[164:167], v[60:63]
  buffer_load_dwordx4 v132, s[52:55], s15 offen offset:2048  lds
  ds_read_b64_tr_b16 a[156:157], v121 offset:8192
  v_mfma_f32_16x16x32_bf16 v[72:75], a[116:119], a[164:167], v[72:75]
  ds_read_b64_tr_b16 a[158:159], v121 offset:9216
  ds_read_b64_tr_b16 a[188:189], v128 offset:0
  v_mfma_f32_16x16x32_bf16 v[84:87], a[120:123], a[164:167], v[84:87]
  ds_read_b64_tr_b16 a[194:195], v128 offset:32
  ds_read_b64_tr_b16 a[200:201], v128 offset:64
  v_mfma_f32_16x16x32_bf16 v[96:99], a[124:127], a[164:167], v[96:99]
  ds_read_b64_tr_b16 a[206:207], v128 offset:96
  ds_read_b64_tr_b16 a[212:213], v128 offset:128
  v_mfma_f32_16x16x32_bf16 v[16:19], a[96:99], a[168:171], v[16:19]
  ds_read_b64_tr_b16 a[218:219], v128 offset:160
  ds_read_b64_tr_b16 a[224:225], v128 offset:192
  v_mfma_f32_16x16x32_bf16 v[28:31], a[100:103], a[168:171], v[28:31]
  buffer_load_dwordx4 v133, s[52:55], s15 offen offset:3072  lds
  ds_read_b64_tr_b16 a[230:231], v128 offset:224
  v_mfma_f32_16x16x32_bf16 v[40:43], a[104:107], a[168:171], v[40:43]
  v_mfma_f32_16x16x32_bf16 v[52:55], a[108:111], a[168:171], v[52:55]
  v_mfma_f32_16x16x32_bf16 v[64:67], a[112:115], a[168:171], v[64:67]
  v_mfma_f32_16x16x32_bf16 v[76:79], a[116:119], a[168:171], v[76:79]
  v_mfma_f32_16x16x32_bf16 v[88:91], a[120:123], a[168:171], v[88:91]
  v_mfma_f32_16x16x32_bf16 v[100:103], a[124:127], a[168:171], v[100:103]
  s_waitcnt lgkmcnt(0)
  v_mfma_f32_16x16x32_bf16 v[8:11], a[128:131], a[172:175], v[8:11]
  s_add_u32 s70, s67, 0
  s_add_u32 s71, s67, 6144
  v_mfma_f32_16x16x32_bf16 v[20:23], a[132:135], a[172:175], v[20:23]
  s_add_u32 s72, s67, 12288
  s_add_u32 s73, s67, 18432
  v_mfma_f32_16x16x32_bf16 v[32:35], a[136:139], a[172:175], v[32:35]
  v_mfma_f32_16x16x32_bf16 v[44:47], a[140:143], a[172:175], v[44:47]
  s_nop 0
  v_cvt_pk_bf16_f32 v140, v8, v9
  v_cvt_pk_bf16_f32 v141, v10, v11
  v_mfma_f32_16x16x32_bf16 v[56:59], a[144:147], a[172:175], v[56:59]
  v_cvt_pk_bf16_f32 v142, v20, v21
  v_cvt_pk_bf16_f32 v143, v22, v23
  v_mfma_f32_16x16x32_bf16 v[68:71], a[148:151], a[172:175], v[68:71]
  v_cvt_pk_bf16_f32 v144, v32, v33
  v_cvt_pk_bf16_f32 v145, v34, v35
  v_mfma_f32_16x16x32_bf16 v[80:83], a[152:155], a[172:175], v[80:83]
  v_cvt_pk_bf16_f32 v146, v44, v45
  v_cvt_pk_bf16_f32 v147, v46, v47
  v_mfma_f32_16x16x32_bf16 v[92:95], a[156:159], a[172:175], v[92:95]
  v_cvt_pk_bf16_f32 v148, v56, v57
  v_cvt_pk_bf16_f32 v149, v58, v59
  v_mfma_f32_16x16x32_bf16 v[188:191], a[0:3], v[140:143], 0
  v_cvt_pk_bf16_f32 v150, v68, v69
  v_cvt_pk_bf16_f32 v151, v70, v71
  v_mfma_f32_16x16x32_bf16 v[192:195], a[16:19], v[140:143], 0
  v_cvt_pk_bf16_f32 v152, v80, v81
  v_cvt_pk_bf16_f32 v153, v82, v83
  v_mfma_f32_16x16x32_bf16 v[196:199], a[32:35], v[140:143], 0
  v_cvt_pk_bf16_f32 v154, v92, v93
  v_cvt_pk_bf16_f32 v155, v94, v95
  v_mfma_f32_16x16x32_bf16 v[188:191], a[4:7], v[144:147], v[188:191]
  v_mfma_f32_16x16x32_bf16 v[192:195], a[20:23], v[144:147], v[192:195]
  v_mfma_f32_16x16x32_bf16 v[196:199], a[36:39], v[144:147], v[196:199]
  v_mfma_f32_16x16x32_bf16 v[188:191], a[8:11], v[148:151], v[188:191]
  v_mfma_f32_16x16x32_bf16 v[192:195], a[24:27], v[148:151], v[192:195]
  v_mfma_f32_16x16x32_bf16 v[196:199], a[40:43], v[148:151], v[196:199]
  v_mfma_f32_16x16x32_bf16 v[188:191], a[12:15], v[152:155], v[188:191]
  v_mfma_f32_16x16x32_bf16 v[192:195], a[28:31], v[152:155], v[192:195]
  v_mfma_f32_16x16x32_bf16 v[196:199], a[44:47], v[152:155], v[196:199]
  v_mfma_f32_16x16x32_bf16 v[12:15], a[128:131], a[176:179], v[12:15]
  v_mfma_f32_16x16x32_bf16 v[24:27], a[132:135], a[176:179], v[24:27]
  v_mfma_f32_16x16x32_bf16 v[36:39], a[136:139], a[176:179], v[36:39]
  v_mfma_f32_16x16x32_bf16 v[48:51], a[140:143], a[176:179], v[48:51]
  s_nop 1
  v_max3_f32 v242, v188, v189, v190
  v_mfma_f32_16x16x32_bf16 v[60:63], a[144:147], a[176:179], v[60:63]
  v_max3_f32 v243, v191, v192, v193
  v_max3_f32 v244, v194, v195, v196
  v_mfma_f32_16x16x32_bf16 v[72:75], a[148:151], a[176:179], v[72:75]
  v_max3_f32 v245, v197, v198, v199
  v_max3_f32 v242, v242, v243, v244
  v_mfma_f32_16x16x32_bf16 v[84:87], a[152:155], a[176:179], v[84:87]
  v_max_f32 v242, v242, v245
  v_mov_b32 v243, v242
  v_mfma_f32_16x16x32_bf16 v[96:99], a[156:159], a[176:179], v[96:99]
  v_cvt_pk_bf16_f32 v156, v12, v13
  v_permlane16_swap_b32 v242, v243
  v_mfma_f32_16x16x32_bf16 v[16:19], a[128:131], a[180:183], v[16:19]
  v_max_f32 v242, v242, v243
  v_mov_b32 v243, v242
  v_mfma_f32_16x16x32_bf16 v[28:31], a[132:135], a[180:183], v[28:31]
  v_cvt_pk_bf16_f32 v157, v14, v15
  v_permlane32_swap_b32 v242, v243
  v_mfma_f32_16x16x32_bf16 v[40:43], a[136:139], a[180:183], v[40:43]
  v_max_f32 v242, v242, v243
  v_mul_f32 v242, s76, v242
  v_mfma_f32_16x16x32_bf16 v[52:55], a[140:143], a[180:183], v[52:55]
  v_fma_f32 v188, v188, s76, -v242
  v_fma_f32 v189, v189, s76, -v242
  v_mfma_f32_16x16x32_bf16 v[64:67], a[144:147], a[180:183], v[64:67]
  v_fma_f32 v190, v190, s76, -v242
  v_fma_f32 v191, v191, s76, -v242
  v_mfma_f32_16x16x32_bf16 v[76:79], a[148:151], a[180:183], v[76:79]
  v_fma_f32 v192, v192, s76, -v242
  v_fma_f32 v193, v193, s76, -v242
  v_mfma_f32_16x16x32_bf16 v[88:91], a[152:155], a[180:183], v[88:91]
  v_fma_f32 v194, v194, s76, -v242
  v_fma_f32 v195, v195, s76, -v242
  v_mfma_f32_16x16x32_bf16 v[100:103], a[156:159], a[180:183], v[100:103]
  v_fma_f32 v196, v196, s76, -v242
  v_fma_f32 v197, v197, s76, -v242
  v_fma_f32 v198, v198, s76, -v242
  v_fma_f32 v199, v199, s76, -v242
  v_exp_f32 v188, v188
  v_exp_f32 v189, v189
  v_exp_f32 v190, v190
  v_exp_f32 v191, v191
  v_exp_f32 v192, v192
  v_exp_f32 v193, v193
  v_exp_f32 v194, v194
  v_exp_f32 v195, v195
  v_exp_f32 v196, v196
  v_exp_f32 v197, v197
  v_exp_f32 v198, v198
  v_exp_f32 v199, v199
  v_add_f32 v243, v188, v189
  v_add_f32 v244, v190, v191
  v_add_f32 v245, v192, v193
  v_add_f32 v242, v194, v195
  v_add_f32 v243, v243, v196
  v_add_f32 v244, v244, v197
  v_add_f32 v245, v245, v198
  v_add_f32 v242, v242, v199
  v_add_f32 v243, v243, v244
  v_add_f32 v242, v242, v245
  v_add_f32 v242, v242, v243
  v_mov_b32 v243, v242
  v_cvt_pk_bf16_f32 v158, v24, v25
  v_cvt_pk_bf16_f32 v159, v26, v27
  v_permlane16_swap_b32 v242, v243
  v_cvt_pk_bf16_f32 v160, v36, v37
  v_mfma_f32_16x16x32_bf16 v[200:203], a[0:3], v[156:159], 0
  v_add_f32 v242, v242, v243
  v_mov_b32 v243, v242
  v_mfma_f32_16x16x32_bf16 v[204:207], a[16:19], v[156:159], 0
  v_cvt_pk_bf16_f32 v161, v38, v39
  v_permlane32_swap_b32 v242, v243
  v_mfma_f32_16x16x32_bf16 v[208:211], a[32:35], v[156:159], 0
  v_add_f32 v242, v242, v243
  v_rcp_f32 v242, v242
  v_cvt_pk_bf16_f32 v162, v48, v49
  v_cvt_pk_bf16_f32 v163, v50, v51
  v_mul_f32 v188, v188, v242
  v_mul_f32 v189, v189, v242
  v_mfma_f32_16x16x32_bf16 v[200:203], a[4:7], v[160:163], v[200:203]
  v_mul_f32 v190, v190, v242
  v_mul_f32 v191, v191, v242
  v_mfma_f32_16x16x32_bf16 v[204:207], a[20:23], v[160:163], v[204:207]
  v_mul_f32 v192, v192, v242
  v_mul_f32 v193, v193, v242
  v_mfma_f32_16x16x32_bf16 v[208:211], a[36:39], v[160:163], v[208:211]
  v_mul_f32 v194, v194, v242
  v_mul_f32 v195, v195, v242
  v_cvt_pk_bf16_f32 v224, v188, v189
  v_cvt_pk_bf16_f32 v225, v190, v191
  v_cvt_pk_bf16_f32 v226, v192, v193
  v_cvt_pk_bf16_f32 v227, v194, v195
  v_mul_f32 v196, v196, v242
  v_mul_f32 v197, v197, v242
  v_mfma_f32_16x16x32_bf16 v[8:11], a[184:187], v[224:227], 0
  v_mul_f32 v198, v198, v242
  v_mul_f32 v199, v199, v242
  v_mfma_f32_16x16x32_bf16 v[20:23], a[190:193], v[224:227], 0
  v_cvt_pk_bf16_f32 v228, v196, v197
  v_cvt_pk_bf16_f32 v229, v198, v199
  v_mfma_f32_16x16x32_bf16 v[32:35], a[196:199], v[224:227], 0
  v_cvt_pk_bf16_f32 v164, v60, v61
  v_cvt_pk_bf16_f32 v165, v62, v63
  v_mfma_f32_16x16x32_bf16 v[44:47], a[202:205], v[224:227], 0
  v_cvt_pk_bf16_f32 v166, v72, v73
  v_cvt_pk_bf16_f32 v167, v74, v75
  v_mfma_f32_16x16x32_bf16 v[56:59], a[208:211], v[224:227], 0
  v_cvt_pk_bf16_f32 v168, v84, v85
  v_cvt_pk_bf16_f32 v169, v86, v87
  v_mfma_f32_16x16x32_bf16 v[68:71], a[214:217], v[224:227], 0
  v_cvt_pk_bf16_f32 v170, v96, v97
  v_cvt_pk_bf16_f32 v171, v98, v99
  v_mfma_f32_16x16x32_bf16 v[80:83], a[220:223], v[224:227], 0
  v_cvt_pk_bf16_f32 v172, v16, v17
  v_cvt_pk_bf16_f32 v173, v18, v19
  v_mfma_f32_16x16x32_bf16 v[92:95], a[226:229], v[224:227], 0
  v_cvt_pk_bf16_f32 v174, v28, v29
  v_cvt_pk_bf16_f32 v175, v30, v31
  v_mfma_f32_16x16x16_bf16 v[8:11], a[188:189], v[228:229], v[8:11]
  v_cvt_pk_bf16_f32 v176, v40, v41
  v_cvt_pk_bf16_f32 v177, v42, v43
  v_mfma_f32_16x16x16_bf16 v[20:23], a[194:195], v[228:229], v[20:23]
  v_cvt_pk_bf16_f32 v178, v52, v53
  v_cvt_pk_bf16_f32 v179, v54, v55
  v_mfma_f32_16x16x16_bf16 v[32:35], a[200:201], v[228:229], v[32:35]
  v_cvt_pk_bf16_f32 v180, v64, v65
  v_cvt_pk_bf16_f32 v181, v66, v67
  v_mfma_f32_16x16x16_bf16 v[44:47], a[206:207], v[228:229], v[44:47]
  v_cvt_pk_bf16_f32 v140, v8, v9
  v_cvt_pk_bf16_f32 v141, v10, v11
  v_mfma_f32_16x16x16_bf16 v[56:59], a[212:213], v[228:229], v[56:59]
  v_cvt_pk_bf16_f32 v142, v20, v21
  v_cvt_pk_bf16_f32 v143, v22, v23
  v_mfma_f32_16x16x16_bf16 v[68:71], a[218:219], v[228:229], v[68:71]
  v_cvt_pk_bf16_f32 v144, v32, v33
  v_cvt_pk_bf16_f32 v145, v34, v35
  v_mfma_f32_16x16x16_bf16 v[80:83], a[224:225], v[228:229], v[80:83]
  v_cvt_pk_bf16_f32 v146, v44, v45
  v_cvt_pk_bf16_f32 v147, v46, v47
  v_mfma_f32_16x16x16_bf16 v[92:95], a[230:231], v[228:229], v[92:95]
  v_cvt_pk_bf16_f32 v148, v56, v57
  v_cvt_pk_bf16_f32 v149, v58, v59
  v_mfma_f32_16x16x32_bf16 v[200:203], a[8:11], v[164:167], v[200:203]
  v_cvt_pk_bf16_f32 v150, v68, v69
  v_cvt_pk_bf16_f32 v151, v70, v71
  v_mfma_f32_16x16x32_bf16 v[204:207], a[24:27], v[164:167], v[204:207]
  v_cvt_pk_bf16_f32 v152, v80, v81
  v_cvt_pk_bf16_f32 v153, v82, v83
  v_mfma_f32_16x16x32_bf16 v[208:211], a[40:43], v[164:167], v[208:211]
  v_cvt_pk_bf16_f32 v154, v92, v93
  v_cvt_pk_bf16_f32 v155, v94, v95
  v_mfma_f32_16x16x32_bf16 v[200:203], a[12:15], v[168:171], v[200:203]
  buffer_store_dwordx4 v[140:143], v124, s[48:51], s70 offen offset:0 sc1
  buffer_store_dwordx4 v[144:147], v124, s[48:51], s71 offen offset:0 sc1
  v_mfma_f32_16x16x32_bf16 v[204:207], a[28:31], v[168:171], v[204:207]
  buffer_store_dwordx4 v[148:151], v124, s[48:51], s72 offen offset:0 sc1
  buffer_store_dwordx4 v[152:155], v124, s[48:51], s73 offen offset:0 sc1
  v_mfma_f32_16x16x32_bf16 v[208:211], a[44:47], v[168:171], v[208:211]
  v_cvt_pk_bf16_f32 v182, v76, v77
  v_cvt_pk_bf16_f32 v183, v78, v79
  v_mfma_f32_16x16x32_bf16 v[212:215], a[0:3], v[172:175], 0
  v_max3_f32 v246, v200, v201, v202
  v_cvt_pk_bf16_f32 v184, v88, v89
  v_mfma_f32_16x16x32_bf16 v[216:219], a[16:19], v[172:175], 0
  v_max3_f32 v247, v203, v204, v205
  v_cvt_pk_bf16_f32 v185, v90, v91
  v_mfma_f32_16x16x32_bf16 v[220:223], a[32:35], v[172:175], 0
  v_max3_f32 v248, v206, v207, v208
  v_max3_f32 v249, v209, v210, v211
  v_mfma_f32_16x16x32_bf16 v[212:215], a[4:7], v[176:179], v[212:215]
  v_max3_f32 v246, v246, v247, v248
  v_max_f32 v246, v246, v249
  v_mfma_f32_16x16x32_bf16 v[216:219], a[20:23], v[176:179], v[216:219]
  v_mov_b32 v247, v246
  v_cvt_pk_bf16_f32 v186, v100, v101
  v_mfma_f32_16x16x32_bf16 v[220:223], a[36:39], v[176:179], v[220:223]
  v_permlane16_swap_b32 v246, v247
  v_cvt_pk_bf16_f32 v187, v102, v103
  v_mfma_f32_16x16x32_bf16 v[212:215], a[8:11], v[180:183], v[212:215]
  v_max_f32 v246, v246, v247
  v_mov_b32 v247, v246
  v_mfma_f32_16x16x32_bf16 v[216:219], a[24:27], v[180:183], v[216:219]
  s_nop 0
  v_permlane32_swap_b32 v246, v247
  v_max_f32 v246, v246, v247
  v_mfma_f32_16x16x32_bf16 v[220:223], a[40:43], v[180:183], v[220:223]
  v_mul_f32 v246, s76, v246
  v_fma_f32 v200, v200, s76, -v246
  v_mfma_f32_16x16x32_bf16 v[212:215], a[12:15], v[184:187], v[212:215]
  v_fma_f32 v201, v201, s76, -v246
  v_fma_f32 v202, v202, s76, -v246
  v_mfma_f32_16x16x32_bf16 v[216:219], a[28:31], v[184:187], v[216:219]
  v_fma_f32 v203, v203, s76, -v246
  v_fma_f32 v204, v204, s76, -v246
  v_mfma_f32_16x16x32_bf16 v[220:223], a[44:47], v[184:187], v[220:223]
  v_fma_f32 v205, v205, s76, -v246
  v_fma_f32 v206, v206, s76, -v246
  v_fma_f32 v207, v207, s76, -v246
  v_fma_f32 v208, v208, s76, -v246
  v_fma_f32 v209, v209, s76, -v246
  v_fma_f32 v210, v210, s76, -v246
  v_fma_f32 v211, v211, s76, -v246
  v_exp_f32 v200, v200
  v_exp_f32 v201, v201
  v_exp_f32 v202, v202
  v_exp_f32 v203, v203
  v_exp_f32 v204, v204
  v_exp_f32 v205, v205
  v_exp_f32 v206, v206
  v_exp_f32 v207, v207
  v_exp_f32 v208, v208
  v_exp_f32 v209, v209
  v_exp_f32 v210, v210
  v_exp_f32 v211, v211
  v_add_f32 v247, v200, v201
  v_add_f32 v248, v202, v203
  v_add_f32 v249, v204, v205
  v_add_f32 v246, v206, v207
  v_add_f32 v247, v247, v208
  v_add_f32 v248, v248, v209
  v_add_f32 v249, v249, v210
  v_add_f32 v246, v246, v211
  v_add_f32 v247, v247, v248
  v_add_f32 v246, v246, v249
  v_add_f32 v246, v246, v247
  v_mov_b32 v247, v246
  v_max3_f32 v250, v212, v213, v214
  v_max3_f32 v251, v215, v216, v217
  v_permlane16_swap_b32 v246, v247
  v_max3_f32 v252, v218, v219, v220
  v_add_f32 v246, v246, v247
  v_mov_b32 v247, v246
  v_max3_f32 v253, v221, v222, v223
  v_max3_f32 v250, v250, v251, v252
  v_permlane32_swap_b32 v246, v247
  v_max_f32 v250, v250, v253
  v_add_f32 v246, v246, v247
  v_rcp_f32 v246, v246
  v_mov_b32 v251, v250
  v_mul_f32 v200, v200, v246
  v_mul_f32 v201, v201, v246
  v_mul_f32 v202, v202, v246
  v_mul_f32 v203, v203, v246
  v_mul_f32 v204, v204, v246
  v_mul_f32 v205, v205, v246
  v_mul_f32 v206, v206, v246
  v_mul_f32 v207, v207, v246
  v_cvt_pk_bf16_f32 v230, v200, v201
  v_cvt_pk_bf16_f32 v231, v202, v203
  v_cvt_pk_bf16_f32 v232, v204, v205
  v_cvt_pk_bf16_f32 v233, v206, v207
  v_mul_f32 v208, v208, v246
  v_mul_f32 v209, v209, v246
  v_mfma_f32_16x16x32_bf16 v[12:15], a[184:187], v[230:233], 0
  v_mul_f32 v210, v210, v246
  v_mul_f32 v211, v211, v246
  v_mfma_f32_16x16x32_bf16 v[24:27], a[190:193], v[230:233], 0
  v_cvt_pk_bf16_f32 v234, v208, v209
  v_cvt_pk_bf16_f32 v235, v210, v211
  v_mfma_f32_16x16x32_bf16 v[36:39], a[196:199], v[230:233], 0
  v_permlane16_swap_b32 v250, v251
  v_mfma_f32_16x16x32_bf16 v[48:51], a[202:205], v[230:233], 0
  v_max_f32 v250, v250, v251
  v_mov_b32 v251, v250
  v_mfma_f32_16x16x32_bf16 v[60:63], a[208:211], v[230:233], 0
  s_nop 0
  v_permlane32_swap_b32 v250, v251
  v_mfma_f32_16x16x32_bf16 v[72:75], a[214:217], v[230:233], 0
  v_max_f32 v250, v250, v251
  v_mul_f32 v250, s76, v250
  v_mfma_f32_16x16x32_bf16 v[84:87], a[220:223], v[230:233], 0
  v_fma_f32 v212, v212, s76, -v250
  v_fma_f32 v213, v213, s76, -v250
  v_mfma_f32_16x16x32_bf16 v[96:99], a[226:229], v[230:233], 0
  v_fma_f32 v214, v214, s76, -v250
  v_fma_f32 v215, v215, s76, -v250
  v_mfma_f32_16x16x16_bf16 v[12:15], a[188:189], v[234:235], v[12:15]
  v_fma_f32 v216, v216, s76, -v250
  v_fma_f32 v217, v217, s76, -v250
  v_mfma_f32_16x16x16_bf16 v[24:27], a[194:195], v[234:235], v[24:27]
  v_fma_f32 v218, v218, s76, -v250
  v_fma_f32 v219, v219, s76, -v250
  v_mfma_f32_16x16x16_bf16 v[36:39], a[200:201], v[234:235], v[36:39]
  v_fma_f32 v220, v220, s76, -v250
  v_fma_f32 v221, v221, s76, -v250
  v_mfma_f32_16x16x16_bf16 v[48:51], a[206:207], v[234:235], v[48:51]
  v_cvt_pk_bf16_f32 v156, v12, v13
  v_cvt_pk_bf16_f32 v157, v14, v15
  v_mfma_f32_16x16x16_bf16 v[60:63], a[212:213], v[234:235], v[60:63]
  v_cvt_pk_bf16_f32 v158, v24, v25
  v_cvt_pk_bf16_f32 v159, v26, v27
  v_mfma_f32_16x16x16_bf16 v[72:75], a[218:219], v[234:235], v[72:75]
  v_cvt_pk_bf16_f32 v160, v36, v37
  v_cvt_pk_bf16_f32 v161, v38, v39
  v_mfma_f32_16x16x16_bf16 v[84:87], a[224:225], v[234:235], v[84:87]
  v_cvt_pk_bf16_f32 v162, v48, v49
  v_cvt_pk_bf16_f32 v163, v50, v51
  v_mfma_f32_16x16x16_bf16 v[96:99], a[230:231], v[234:235], v[96:99]
  v_cvt_pk_bf16_f32 v164, v60, v61
  v_cvt_pk_bf16_f32 v165, v62, v63
  v_cvt_pk_bf16_f32 v166, v72, v73
  v_cvt_pk_bf16_f32 v167, v74, v75
  buffer_store_dwordx4 v[156:159], v124, s[48:51], s70 offen offset:1024 sc1
  v_cvt_pk_bf16_f32 v168, v84, v85
  v_cvt_pk_bf16_f32 v169, v86, v87
  buffer_store_dwordx4 v[160:163], v124, s[48:51], s71 offen offset:1024 sc1
  v_cvt_pk_bf16_f32 v170, v96, v97
  v_cvt_pk_bf16_f32 v171, v98, v99
  buffer_store_dwordx4 v[164:167], v124, s[48:51], s72 offen offset:1024 sc1
  buffer_store_dwordx4 v[168:171], v124, s[48:51], s73 offen offset:1024 sc1
  v_fma_f32 v222, v222, s76, -v250
  v_fma_f32 v223, v223, s76, -v250
  v_exp_f32 v212, v212
  v_exp_f32 v213, v213
  v_exp_f32 v214, v214
  v_exp_f32 v215, v215
  v_exp_f32 v216, v216
  v_exp_f32 v217, v217
  v_exp_f32 v218, v218
  v_exp_f32 v219, v219
  v_exp_f32 v220, v220
  v_exp_f32 v221, v221
  v_exp_f32 v222, v222
  v_exp_f32 v223, v223
  v_add_f32 v251, v212, v213
  v_add_f32 v252, v214, v215
  v_add_f32 v253, v216, v217
  v_add_f32 v250, v218, v219
  v_add_f32 v251, v251, v220
  v_add_f32 v252, v252, v221
  v_add_f32 v253, v253, v222
  v_add_f32 v250, v250, v223
  v_add_f32 v251, v251, v252
  v_add_f32 v250, v250, v253
  v_add_f32 v250, v250, v251
  v_mov_b32 v251, v250
  s_nop 1
  v_permlane16_swap_b32 v250, v251
  v_add_f32 v250, v250, v251
  v_mov_b32 v251, v250
  s_nop 1
  v_permlane32_swap_b32 v250, v251
  v_add_f32 v250, v250, v251
  v_rcp_f32 v250, v250
  s_nop 0
  v_mul_f32 v212, v212, v250
  v_mul_f32 v213, v213, v250
  v_mul_f32 v214, v214, v250
  v_mul_f32 v215, v215, v250
  v_mul_f32 v216, v216, v250
  v_mul_f32 v217, v217, v250
  v_mul_f32 v218, v218, v250
  v_mul_f32 v219, v219, v250
  v_cvt_pk_bf16_f32 v236, v212, v213
  v_cvt_pk_bf16_f32 v237, v214, v215
  v_cvt_pk_bf16_f32 v238, v216, v217
  v_cvt_pk_bf16_f32 v239, v218, v219
  v_mul_f32 v220, v220, v250
  v_mul_f32 v221, v221, v250
  v_mfma_f32_16x16x32_bf16 v[16:19], a[184:187], v[236:239], 0
  v_mul_f32 v222, v222, v250
  v_mul_f32 v223, v223, v250
  v_mfma_f32_16x16x32_bf16 v[28:31], a[190:193], v[236:239], 0
  v_cvt_pk_bf16_f32 v240, v220, v221
  v_cvt_pk_bf16_f32 v241, v222, v223
  v_mfma_f32_16x16x32_bf16 v[40:43], a[196:199], v[236:239], 0
  v_mfma_f32_16x16x32_bf16 v[52:55], a[202:205], v[236:239], 0
  v_mfma_f32_16x16x32_bf16 v[64:67], a[208:211], v[236:239], 0
  v_mfma_f32_16x16x32_bf16 v[76:79], a[214:217], v[236:239], 0
  v_mfma_f32_16x16x32_bf16 v[88:91], a[220:223], v[236:239], 0
  v_mfma_f32_16x16x32_bf16 v[100:103], a[226:229], v[236:239], 0
  v_mfma_f32_16x16x16_bf16 v[16:19], a[188:189], v[240:241], v[16:19]
  v_mfma_f32_16x16x16_bf16 v[28:31], a[194:195], v[240:241], v[28:31]
  v_mfma_f32_16x16x16_bf16 v[40:43], a[200:201], v[240:241], v[40:43]
  v_mfma_f32_16x16x16_bf16 v[52:55], a[206:207], v[240:241], v[52:55]
  v_mfma_f32_16x16x16_bf16 v[64:67], a[212:213], v[240:241], v[64:67]
  v_mfma_f32_16x16x16_bf16 v[76:79], a[218:219], v[240:241], v[76:79]
  v_mfma_f32_16x16x16_bf16 v[88:91], a[224:225], v[240:241], v[88:91]
  v_mfma_f32_16x16x16_bf16 v[100:103], a[230:231], v[240:241], v[100:103]
  s_nop 0
  v_cvt_pk_bf16_f32 v172, v16, v17
  v_cvt_pk_bf16_f32 v173, v18, v19
  v_cvt_pk_bf16_f32 v174, v28, v29
  v_cvt_pk_bf16_f32 v175, v30, v31
  v_cvt_pk_bf16_f32 v176, v40, v41
  v_cvt_pk_bf16_f32 v177, v42, v43
  v_cvt_pk_bf16_f32 v178, v52, v53
  v_cvt_pk_bf16_f32 v179, v54, v55
  v_cvt_pk_bf16_f32 v180, v64, v65
  v_cvt_pk_bf16_f32 v181, v66, v67
  v_cvt_pk_bf16_f32 v182, v76, v77
  v_cvt_pk_bf16_f32 v183, v78, v79
  v_cvt_pk_bf16_f32 v184, v88, v89
  v_cvt_pk_bf16_f32 v185, v90, v91
  v_cvt_pk_bf16_f32 v186, v100, v101
  v_cvt_pk_bf16_f32 v187, v102, v103
  buffer_store_dwordx4 v[172:175], v124, s[48:51], s70 offen offset:2048 sc1
  buffer_store_dwordx4 v[176:179], v124, s[48:51], s71 offen offset:2048 sc1
  buffer_store_dwordx4 v[180:183], v124, s[48:51], s72 offen offset:2048 sc1
  buffer_store_dwordx4 v[184:187], v124, s[48:51], s73 offen offset:2048 sc1
  s_waitcnt vmcnt(28)
  v_add_u32 v4, s40, v134
  v_add_u32 v5, s40, v135
  v_add_u32 v6, s40, v136
  v_add_u32 v7, s40, v137
  ds_read_b64_tr_b16 a[48:49], v4 offset:0
  ds_read_b64_tr_b16 a[50:51], v4 offset:2048
  ds_read_b64_tr_b16 a[52:53], v5 offset:0
  ds_read_b64_tr_b16 a[54:55], v5 offset:2048
  ds_read_b64_tr_b16 a[56:57], v6 offset:0
  ds_read_b64_tr_b16 a[58:59], v6 offset:2048
  ds_read_b64_tr_b16 a[60:61], v7 offset:0
  ds_read_b64_tr_b16 a[62:63], v7 offset:2048
  s_waitcnt vmcnt(24)
  v_add_u32 v4, s41, v134
  v_add_u32 v5, s41, v135
  v_add_u32 v6, s41, v136
  v_add_u32 v7, s41, v137
  ds_read_b64_tr_b16 a[64:65], v4 offset:0
  ds_read_b64_tr_b16 a[66:67], v4 offset:2048
  ds_read_b64_tr_b16 a[68:69], v5 offset:0
  ds_read_b64_tr_b16 a[70:71], v5 offset:2048
  ds_read_b64_tr_b16 a[72:73], v6 offset:0
  ds_read_b64_tr_b16 a[74:75], v6 offset:2048
  ds_read_b64_tr_b16 a[76:77], v7 offset:0
  ds_read_b64_tr_b16 a[78:79], v7 offset:2048
  s_waitcnt vmcnt(20)
  v_add_u32 v4, s42, v134
  v_add_u32 v5, s42, v135
  v_add_u32 v6, s42, v136
  v_add_u32 v7, s42, v137
  ds_read_b64_tr_b16 a[80:81], v4 offset:0
  ds_read_b64_tr_b16 a[82:83], v4 offset:2048
  ds_read_b64_tr_b16 a[84:85], v5 offset:0
  ds_read_b64_tr_b16 a[86:87], v5 offset:2048
  ds_read_b64_tr_b16 a[88:89], v6 offset:0
  ds_read_b64_tr_b16 a[90:91], v6 offset:2048
  ds_read_b64_tr_b16 a[92:93], v7 offset:0
  ds_read_b64_tr_b16 a[94:95], v7 offset:2048
  s_waitcnt vmcnt(0)
  s_waitcnt lgkmcnt(0)
  s_barrier
  s_cmp_lg_u32 s3, 0
  s_cbranch_scc1 L_nosig_ached__near_ridge_kernel
  v_mov_b32 v1, 1
  v_mov_b32 v2, 0
  s_mov_b64 exec, 1
  buffer_atomic_add v1, v2, s[60:63], s100 offen sc1
  s_mov_b64 exec, -1
L_nosig_ached__near_ridge_kernel:
  v_mov_b32 v2, 0
  s_mov_b32 m0, s74
  s_add_u32 s15, s14, 5
  s_and_b32 s15, s15, 7
  s_lshl_b32 s15, s15, 16
  s_add_u32 s15, s15, s9
  buffer_load_dwordx4 v130, s[52:55], s15 offen offset:0  lds
  buffer_load_dwordx4 v131, s[52:55], s15 offen offset:1024  lds
  buffer_load_dwordx4 v132, s[52:55], s15 offen offset:2048  lds
  buffer_load_dwordx4 v133, s[52:55], s15 offen offset:3072  lds
  s_mov_b32 m0, s17
  s_add_u32 s15, s14, 6
  s_and_b32 s15, s15, 7
  s_lshl_b32 s15, s15, 16
  s_add_u32 s15, s15, s9
  buffer_load_dwordx4 v130, s[52:55], s15 offen offset:0  lds
  buffer_load_dwordx4 v131, s[52:55], s15 offen offset:1024  lds
  buffer_load_dwordx4 v132, s[52:55], s15 offen offset:2048  lds
  buffer_load_dwordx4 v133, s[52:55], s15 offen offset:3072  lds
  s_mov_b32 m0, s10
  s_add_u32 s15, s14, 7
  s_and_b32 s15, s15, 7
  s_lshl_b32 s15, s15, 16
  s_add_u32 s15, s15, s9
  buffer_load_dwordx4 v130, s[52:55], s15 offen offset:0  lds
  buffer_load_dwordx4 v131, s[52:55], s15 offen offset:1024  lds
  buffer_load_dwordx4 v132, s[52:55], s15 offen offset:2048  lds
  buffer_load_dwordx4 v133, s[52:55], s15 offen offset:3072  lds
  s_mov_b32 m0, s11
  s_add_u32 s15, s14, 0
  s_and_b32 s15, s15, 7
  s_or_b32 s15, s15, 8
  s_lshl_b32 s15, s15, 16
  s_add_u32 s15, s15, s9
  buffer_load_dwordx4 v130, s[52:55], s15 offen offset:0  lds
  buffer_load_dwordx4 v131, s[52:55], s15 offen offset:1024  lds
  buffer_load_dwordx4 v132, s[52:55], s15 offen offset:2048  lds
  buffer_load_dwordx4 v133, s[52:55], s15 offen offset:3072  lds
  s_mov_b32 m0, s16
  s_add_u32 s15, s14, 1
  s_and_b32 s15, s15, 7
  s_or_b32 s15, s15, 8
  s_lshl_b32 s15, s15, 16
  s_add_u32 s15, s15, s9
  buffer_load_dwordx4 v130, s[52:55], s15 offen offset:0  lds
  buffer_load_dwordx4 v131, s[52:55], s15 offen offset:1024  lds
  buffer_load_dwordx4 v132, s[52:55], s15 offen offset:2048  lds
  buffer_load_dwordx4 v133, s[52:55], s15 offen offset:3072  lds
  s_mov_b32 m0, s40
  s_add_u32 s15, s14, 2
  s_and_b32 s15, s15, 7
  s_or_b32 s15, s15, 8
  s_lshl_b32 s15, s15, 16
  s_add_u32 s15, s15, s9
  buffer_load_dwordx4 v130, s[52:55], s15 offen offset:0  lds
  buffer_load_dwordx4 v131, s[52:55], s15 offen offset:1024  lds
  buffer_load_dwordx4 v132, s[52:55], s15 offen offset:2048  lds
  buffer_load_dwordx4 v133, s[52:55], s15 offen offset:3072  lds
  s_mov_b32 m0, s41
  s_add_u32 s15, s14, 3
  s_and_b32 s15, s15, 7
  s_or_b32 s15, s15, 8
  s_lshl_b32 s15, s15, 16
  s_add_u32 s15, s15, s9
  buffer_load_dwordx4 v130, s[52:55], s15 offen offset:0  lds
  buffer_load_dwordx4 v131, s[52:55], s15 offen offset:1024  lds
  buffer_load_dwordx4 v132, s[52:55], s15 offen offset:2048  lds
  buffer_load_dwordx4 v133, s[52:55], s15 offen offset:3072  lds
  s_mov_b32 m0, s42
  s_add_u32 s15, s14, 4
  s_and_b32 s15, s15, 7
  s_or_b32 s15, s15, 8
  s_lshl_b32 s15, s15, 16
  s_add_u32 s15, s15, s9
  buffer_load_dwordx4 v130, s[52:55], s15 offen offset:0  lds
  buffer_load_dwordx4 v131, s[52:55], s15 offen offset:1024  lds
  buffer_load_dwordx4 v132, s[52:55], s15 offen offset:2048  lds
  buffer_load_dwordx4 v133, s[52:55], s15 offen offset:3072  lds
  v_add_u32 v4, s43, v134
  v_add_u32 v5, s43, v135
  v_add_u32 v6, s43, v136
  v_add_u32 v7, s43, v137
  ds_read_b64_tr_b16 a[96:97], v4 offset:0
  ds_read_b64_tr_b16 a[98:99], v4 offset:2048
  ds_read_b64_tr_b16 a[100:101], v5 offset:0
  ds_read_b64_tr_b16 a[102:103], v5 offset:2048
  ds_read_b64_tr_b16 a[104:105], v6 offset:0
  ds_read_b64_tr_b16 a[106:107], v6 offset:2048
  ds_read_b64_tr_b16 a[108:109], v7 offset:0
  ds_read_b64_tr_b16 a[110:111], v7 offset:2048
  v_add_u32 v4, s66, v134
  v_add_u32 v5, s66, v135
  v_add_u32 v6, s66, v136
  v_add_u32 v7, s66, v137
  ds_read_b64_tr_b16 a[112:113], v4 offset:0
  ds_read_b64_tr_b16 a[114:115], v4 offset:2048
  ds_read_b64_tr_b16 a[116:117], v5 offset:0
  ds_read_b64_tr_b16 a[118:119], v5 offset:2048
  ds_read_b64_tr_b16 a[120:121], v6 offset:0
  ds_read_b64_tr_b16 a[122:123], v6 offset:2048
  ds_read_b64_tr_b16 a[124:125], v7 offset:0
  ds_read_b64_tr_b16 a[126:127], v7 offset:2048
  s_waitcnt lgkmcnt(8)
  s_mov_b32 m0, s43
  s_add_u32 s15, s14, 5
  s_and_b32 s15, s15, 7
  s_or_b32 s15, s15, 8
  s_lshl_b32 s15, s15, 16
  s_add_u32 s15, s15, s9
  buffer_load_dwordx4 v130, s[52:55], s15 offen offset:0  lds
  buffer_load_dwordx4 v131, s[52:55], s15 offen offset:1024  lds
  buffer_load_dwordx4 v132, s[52:55], s15 offen offset:2048  lds
  buffer_load_dwordx4 v133, s[52:55], s15 offen offset:3072  lds
  s_waitcnt vmcnt(32)
  v_add_u32 v4, s74, v134
  v_add_u32 v5, s74, v135
  v_add_u32 v6, s74, v136
  v_add_u32 v7, s74, v137
  ds_read_b64_tr_b16 a[128:129], v4 offset:0
  ds_read_b64_tr_b16 a[130:131], v4 offset:2048
  ds_read_b64_tr_b16 a[132:133], v5 offset:0
  ds_read_b64_tr_b16 a[134:135], v5 offset:2048
  ds_read_b64_tr_b16 a[136:137], v6 offset:0
  ds_read_b64_tr_b16 a[138:139], v6 offset:2048
  ds_read_b64_tr_b16 a[140:141], v7 offset:0
  ds_read_b64_tr_b16 a[142:143], v7 offset:2048
  s_waitcnt lgkmcnt(8)
  s_mov_b32 m0, s66
  s_add_u32 s15, s14, 6
  s_and_b32 s15, s15, 7
  s_or_b32 s15, s15, 8
  s_lshl_b32 s15, s15, 16
  s_add_u32 s15, s15, s9
  buffer_load_dwordx4 v130, s[52:55], s15 offen offset:0  lds
  buffer_load_dwordx4 v131, s[52:55], s15 offen offset:1024  lds
  buffer_load_dwordx4 v132, s[52:55], s15 offen offset:2048  lds
  buffer_load_dwordx4 v133, s[52:55], s15 offen offset:3072  lds
  s_waitcnt vmcnt(32)
  v_add_u32 v4, s17, v134
  v_add_u32 v5, s17, v135
  v_add_u32 v6, s17, v136
  v_add_u32 v7, s17, v137
  ds_read_b64_tr_b16 a[144:145], v4 offset:0
  ds_read_b64_tr_b16 a[146:147], v4 offset:2048
  ds_read_b64_tr_b16 a[148:149], v5 offset:0
  ds_read_b64_tr_b16 a[150:151], v5 offset:2048
  ds_read_b64_tr_b16 a[152:153], v6 offset:0
  ds_read_b64_tr_b16 a[154:155], v6 offset:2048
  ds_read_b64_tr_b16 a[156:157], v7 offset:0
  ds_read_b64_tr_b16 a[158:159], v7 offset:2048
  s_waitcnt lgkmcnt(8)
  s_mov_b32 m0, s74
  s_add_u32 s15, s14, 7
  s_and_b32 s15, s15, 7
  s_or_b32 s15, s15, 8
  s_lshl_b32 s15, s15, 16
  s_add_u32 s15, s15, s9
  buffer_load_dwordx4 v130, s[52:55], s15 offen offset:0  lds
  buffer_load_dwordx4 v131, s[52:55], s15 offen offset:1024  lds
  buffer_load_dwordx4 v132, s[52:55], s15 offen offset:2048  lds
  buffer_load_dwordx4 v133, s[52:55], s15 offen offset:3072  lds
  s_waitcnt vmcnt(32)
  v_add_u32 v4, s10, v134
  v_add_u32 v5, s10, v135
  v_add_u32 v6, s10, v136
  v_add_u32 v7, s10, v137
  ds_read_b64_tr_b16 a[160:161], v4 offset:0
  ds_read_b64_tr_b16 a[162:163], v4 offset:2048
  ds_read_b64_tr_b16 a[164:165], v5 offset:0
  ds_read_b64_tr_b16 a[166:167], v5 offset:2048
  ds_read_b64_tr_b16 a[168:169], v6 offset:0
  ds_read_b64_tr_b16 a[170:171], v6 offset:2048
  ds_read_b64_tr_b16 a[172:173], v7 offset:0
  ds_read_b64_tr_b16 a[174:175], v7 offset:2048
  s_waitcnt lgkmcnt(8)
  s_mov_b32 m0, s17
  s_add_u32 s15, s14, 0
  s_and_b32 s15, s15, 7
  s_or_b32 s15, s15, 16
  s_lshl_b32 s15, s15, 16
  s_add_u32 s15, s15, s9
  buffer_load_dwordx4 v130, s[52:55], s15 offen offset:0  lds
  buffer_load_dwordx4 v131, s[52:55], s15 offen offset:1024  lds
  buffer_load_dwordx4 v132, s[52:55], s15 offen offset:2048  lds
  buffer_load_dwordx4 v133, s[52:55], s15 offen offset:3072  lds
  s_waitcnt vmcnt(32)
  v_add_u32 v4, s11, v134
  v_add_u32 v5, s11, v135
  v_add_u32 v6, s11, v136
  v_add_u32 v7, s11, v137
  ds_read_b64_tr_b16 a[176:177], v4 offset:0
  ds_read_b64_tr_b16 a[178:179], v4 offset:2048
  ds_read_b64_tr_b16 a[180:181], v5 offset:0
  ds_read_b64_tr_b16 a[182:183], v5 offset:2048
  ds_read_b64_tr_b16 a[232:233], v6 offset:0
  ds_read_b64_tr_b16 a[234:235], v6 offset:2048
  ds_read_b64_tr_b16 a[236:237], v7 offset:0
  ds_read_b64_tr_b16 a[238:239], v7 offset:2048
  s_waitcnt lgkmcnt(8)
  s_mov_b32 m0, s10
  s_add_u32 s15, s14, 1
  s_and_b32 s15, s15, 7
  s_or_b32 s15, s15, 16
  s_lshl_b32 s15, s15, 16
  s_add_u32 s15, s15, s9
  buffer_load_dwordx4 v130, s[52:55], s15 offen offset:0  lds
  buffer_load_dwordx4 v131, s[52:55], s15 offen offset:1024  lds
  buffer_load_dwordx4 v132, s[52:55], s15 offen offset:2048  lds
  buffer_load_dwordx4 v133, s[52:55], s15 offen offset:3072  lds
  s_waitcnt vmcnt(32)
  v_add_u32 v4, s16, v134
  v_add_u32 v5, s16, v135
  v_add_u32 v6, s16, v136
  v_add_u32 v7, s16, v137
  ds_read_b64_tr_b16 a[240:241], v4 offset:0
  ds_read_b64_tr_b16 a[242:243], v4 offset:2048
  ds_read_b64_tr_b16 a[244:245], v5 offset:0
  ds_read_b64_tr_b16 a[246:247], v5 offset:2048
  ds_read_b64_tr_b16 a[248:249], v6 offset:0
  ds_read_b64_tr_b16 a[250:251], v6 offset:2048
  ds_read_b64_tr_b16 a[252:253], v7 offset:0
  ds_read_b64_tr_b16 a[254:255], v7 offset:2048
  s_waitcnt lgkmcnt(8)
  s_mov_b32 m0, s11
  s_add_u32 s15, s14, 2
  s_and_b32 s15, s15, 7
  s_or_b32 s15, s15, 16
  s_lshl_b32 s15, s15, 16
  s_add_u32 s15, s15, s9
  buffer_load_dwordx4 v130, s[52:55], s15 offen offset:0  lds
  buffer_load_dwordx4 v131, s[52:55], s15 offen offset:1024  lds
  buffer_load_dwordx4 v132, s[52:55], s15 offen offset:2048  lds
  buffer_load_dwordx4 v133, s[52:55], s15 offen offset:3072  lds
  s_waitcnt vmcnt(32)
  v_add_u32 v4, s40, v134
  v_add_u32 v5, s40, v135
  v_add_u32 v6, s40, v136
  v_add_u32 v7, s40, v137
  ds_read_b64_tr_b16 a[0:1], v4 offset:0
  ds_read_b64_tr_b16 a[2:3], v4 offset:2048
  ds_read_b64_tr_b16 a[4:5], v5 offset:0
  ds_read_b64_tr_b16 a[6:7], v5 offset:2048
  ds_read_b64_tr_b16 a[8:9], v6 offset:0
  ds_read_b64_tr_b16 a[10:11], v6 offset:2048
  ds_read_b64_tr_b16 a[12:13], v7 offset:0
  ds_read_b64_tr_b16 a[14:15], v7 offset:2048
  s_waitcnt lgkmcnt(8)
  s_mov_b32 m0, s16
  s_add_u32 s15, s14, 3
  s_and_b32 s15, s15, 7
  s_or_b32 s15, s15, 16
  s_lshl_b32 s15, s15, 16
  s_add_u32 s15, s15, s9
  buffer_load_dwordx4 v130, s[52:55], s15 offen offset:0  lds
  buffer_load_dwordx4 v131, s[52:55], s15 offen offset:1024  lds
  buffer_load_dwordx4 v132, s[52:55], s15 offen offset:2048  lds
  buffer_load_dwordx4 v133, s[52:55], s15 offen offset:3072  lds
  s_waitcnt vmcnt(32)
  v_add_u32 v4, s41, v134
  v_add_u32 v5, s41, v135
  v_add_u32 v6, s41, v136
  v_add_u32 v7, s41, v137
  ds_read_b64_tr_b16 a[16:17], v4 offset:0
  ds_read_b64_tr_b16 a[18:19], v4 offset:2048
  ds_read_b64_tr_b16 a[20:21], v5 offset:0
  ds_read_b64_tr_b16 a[22:23], v5 offset:2048
  ds_read_b64_tr_b16 a[24:25], v6 offset:0
  ds_read_b64_tr_b16 a[26:27], v6 offset:2048
  ds_read_b64_tr_b16 a[28:29], v7 offset:0
  ds_read_b64_tr_b16 a[30:31], v7 offset:2048
  s_waitcnt lgkmcnt(8)
  s_mov_b32 m0, s40
  s_add_u32 s15, s14, 4
  s_and_b32 s15, s15, 7
  s_or_b32 s15, s15, 16
  s_lshl_b32 s15, s15, 16
  s_add_u32 s15, s15, s9
  buffer_load_dwordx4 v130, s[52:55], s15 offen offset:0  lds
  buffer_load_dwordx4 v131, s[52:55], s15 offen offset:1024  lds
  buffer_load_dwordx4 v132, s[52:55], s15 offen offset:2048  lds
  buffer_load_dwordx4 v133, s[52:55], s15 offen offset:3072  lds
  s_waitcnt vmcnt(32)
  v_add_u32 v4, s42, v134
  v_add_u32 v5, s42, v135
  v_add_u32 v6, s42, v136
  v_add_u32 v7, s42, v137
  ds_read_b64_tr_b16 a[32:33], v4 offset:0
  ds_read_b64_tr_b16 a[34:35], v4 offset:2048
  ds_read_b64_tr_b16 a[36:37], v5 offset:0
  ds_read_b64_tr_b16 a[38:39], v5 offset:2048
  ds_read_b64_tr_b16 a[40:41], v6 offset:0
  ds_read_b64_tr_b16 a[42:43], v6 offset:2048
  ds_read_b64_tr_b16 a[44:45], v7 offset:0
  ds_read_b64_tr_b16 a[46:47], v7 offset:2048
  s_waitcnt lgkmcnt(8)
  s_mov_b32 m0, s41
  s_add_u32 s15, s14, 5
  s_and_b32 s15, s15, 7
  s_or_b32 s15, s15, 16
  s_lshl_b32 s15, s15, 16
  s_add_u32 s15, s15, s9
  buffer_load_dwordx4 v130, s[52:55], s15 offen offset:0  lds
  buffer_load_dwordx4 v131, s[52:55], s15 offen offset:1024  lds
  buffer_load_dwordx4 v132, s[52:55], s15 offen offset:2048  lds
  buffer_load_dwordx4 v133, s[52:55], s15 offen offset:3072  lds
  s_waitcnt vmcnt(32)
  v_add_u32 v4, s43, v134
  v_add_u32 v5, s43, v135
  v_add_u32 v6, s43, v136
  v_add_u32 v7, s43, v137
  ds_read_b64_tr_b16 a[184:185], v4 offset:0
  ds_read_b64_tr_b16 a[186:187], v4 offset:2048
  ds_read_b64_tr_b16 a[188:189], v5 offset:0
  ds_read_b64_tr_b16 a[190:191], v5 offset:2048
  ds_read_b64_tr_b16 a[192:193], v6 offset:0
  ds_read_b64_tr_b16 a[194:195], v6 offset:2048
  ds_read_b64_tr_b16 a[196:197], v7 offset:0
  ds_read_b64_tr_b16 a[198:199], v7 offset:2048
  s_waitcnt lgkmcnt(8)
  s_mov_b32 m0, s42
  s_add_u32 s15, s14, 6
  s_and_b32 s15, s15, 7
  s_or_b32 s15, s15, 16
  s_lshl_b32 s15, s15, 16
  s_add_u32 s15, s15, s9
  buffer_load_dwordx4 v130, s[52:55], s15 offen offset:0  lds
  buffer_load_dwordx4 v131, s[52:55], s15 offen offset:1024  lds
  buffer_load_dwordx4 v132, s[52:55], s15 offen offset:2048  lds
  buffer_load_dwordx4 v133, s[52:55], s15 offen offset:3072  lds
  s_waitcnt vmcnt(32)
  v_add_u32 v4, s66, v134
  v_add_u32 v5, s66, v135
  v_add_u32 v6, s66, v136
  v_add_u32 v7, s66, v137
  ds_read_b64_tr_b16 a[200:201], v4 offset:0
  ds_read_b64_tr_b16 a[202:203], v4 offset:2048
  ds_read_b64_tr_b16 a[204:205], v5 offset:0
  ds_read_b64_tr_b16 a[206:207], v5 offset:2048
  ds_read_b64_tr_b16 a[208:209], v6 offset:0
  ds_read_b64_tr_b16 a[210:211], v6 offset:2048
  ds_read_b64_tr_b16 a[212:213], v7 offset:0
  ds_read_b64_tr_b16 a[214:215], v7 offset:2048
  s_waitcnt lgkmcnt(8)
  s_mov_b32 m0, s43
  s_add_u32 s15, s14, 7
  s_and_b32 s15, s15, 7
  s_or_b32 s15, s15, 16
  s_lshl_b32 s15, s15, 16
  s_add_u32 s15, s15, s9
  buffer_load_dwordx4 v130, s[52:55], s15 offen offset:0  lds
  buffer_load_dwordx4 v131, s[52:55], s15 offen offset:1024  lds
  buffer_load_dwordx4 v132, s[52:55], s15 offen offset:2048  lds
  buffer_load_dwordx4 v133, s[52:55], s15 offen offset:3072  lds
  s_waitcnt vmcnt(32)
  v_add_u32 v4, s74, v134
  v_add_u32 v5, s74, v135
  v_add_u32 v6, s74, v136
  v_add_u32 v7, s74, v137
  ds_read_b64_tr_b16 a[216:217], v4 offset:0
  ds_read_b64_tr_b16 a[218:219], v4 offset:2048
  ds_read_b64_tr_b16 a[220:221], v5 offset:0
  ds_read_b64_tr_b16 a[222:223], v5 offset:2048
  ds_read_b64_tr_b16 a[224:225], v6 offset:0
  ds_read_b64_tr_b16 a[226:227], v6 offset:2048
  ds_read_b64_tr_b16 a[228:229], v7 offset:0
  ds_read_b64_tr_b16 a[230:231], v7 offset:2048
  s_waitcnt lgkmcnt(8)
  s_mov_b32 m0, s66
  s_add_u32 s15, s14, 0
  s_and_b32 s15, s15, 7
  s_or_b32 s15, s15, 24
  s_lshl_b32 s15, s15, 16
  s_add_u32 s15, s15, s9
  buffer_load_dwordx4 v130, s[52:55], s15 offen offset:0  lds
  buffer_load_dwordx4 v131, s[52:55], s15 offen offset:1024  lds
  buffer_load_dwordx4 v132, s[52:55], s15 offen offset:2048  lds
  buffer_load_dwordx4 v133, s[52:55], s15 offen offset:3072  lds
  s_waitcnt vmcnt(32)
  v_add_u32 v4, s17, v134
  v_add_u32 v5, s17, v135
  v_add_u32 v6, s17, v136
  v_add_u32 v7, s17, v137
  ds_read_b64_tr_b16 v[188:189], v4 offset:0
  ds_read_b64_tr_b16 v[190:191], v4 offset:2048
  ds_read_b64_tr_b16 v[192:193], v5 offset:0
  ds_read_b64_tr_b16 v[194:195], v5 offset:2048
  ds_read_b64_tr_b16 v[196:197], v6 offset:0
  ds_read_b64_tr_b16 v[198:199], v6 offset:2048
  ds_read_b64_tr_b16 v[200:201], v7 offset:0
  ds_read_b64_tr_b16 v[202:203], v7 offset:2048
  s_waitcnt lgkmcnt(8)
  s_mov_b32 m0, s74
  s_add_u32 s15, s14, 1
  s_and_b32 s15, s15, 7
  s_or_b32 s15, s15, 24
  s_lshl_b32 s15, s15, 16
  s_add_u32 s15, s15, s9
  buffer_load_dwordx4 v130, s[52:55], s15 offen offset:0  lds
  buffer_load_dwordx4 v131, s[52:55], s15 offen offset:1024  lds
  buffer_load_dwordx4 v132, s[52:55], s15 offen offset:2048  lds
  buffer_load_dwordx4 v133, s[52:55], s15 offen offset:3072  lds
  s_waitcnt vmcnt(32)
  v_add_u32 v4, s10, v134
  v_add_u32 v5, s10, v135
  v_add_u32 v6, s10, v136
  v_add_u32 v7, s10, v137
  ds_read_b64_tr_b16 v[204:205], v4 offset:0
  ds_read_b64_tr_b16 v[206:207], v4 offset:2048
  ds_read_b64_tr_b16 v[208:209], v5 offset:0
  ds_read_b64_tr_b16 v[210:211], v5 offset:2048
  ds_read_b64_tr_b16 v[212:213], v6 offset:0
  ds_read_b64_tr_b16 v[214:215], v6 offset:2048
  ds_read_b64_tr_b16 v[216:217], v7 offset:0
  ds_read_b64_tr_b16 v[218:219], v7 offset:2048
  s_waitcnt lgkmcnt(8)
  s_mov_b32 m0, s17
  s_add_u32 s15, s14, 2
  s_and_b32 s15, s15, 7
  s_or_b32 s15, s15, 24
  s_lshl_b32 s15, s15, 16
  s_add_u32 s15, s15, s9
  buffer_load_dwordx4 v130, s[52:55], s15 offen offset:0  lds
  buffer_load_dwordx4 v131, s[52:55], s15 offen offset:1024  lds
  buffer_load_dwordx4 v132, s[52:55], s15 offen offset:2048  lds
  buffer_load_dwordx4 v133, s[52:55], s15 offen offset:3072  lds
  s_waitcnt vmcnt(32)
  v_add_u32 v4, s11, v134
  v_add_u32 v5, s11, v135
  v_add_u32 v6, s11, v136
  v_add_u32 v7, s11, v137
  ds_read_b64_tr_b16 v[220:221], v4 offset:0
  ds_read_b64_tr_b16 v[222:223], v4 offset:2048
  ds_read_b64_tr_b16 v[224:225], v5 offset:0
  ds_read_b64_tr_b16 v[226:227], v5 offset:2048
  ds_read_b64_tr_b16 v[228:229], v6 offset:0
  ds_read_b64_tr_b16 v[230:231], v6 offset:2048
  ds_read_b64_tr_b16 v[232:233], v7 offset:0
  ds_read_b64_tr_b16 v[234:235], v7 offset:2048
  s_waitcnt lgkmcnt(8)
  s_mov_b32 m0, s10
  s_add_u32 s15, s14, 3
  s_and_b32 s15, s15, 7
  s_or_b32 s15, s15, 24
  s_lshl_b32 s15, s15, 16
  s_add_u32 s15, s15, s9
  buffer_load_dwordx4 v130, s[52:55], s15 offen offset:0  lds
  buffer_load_dwordx4 v131, s[52:55], s15 offen offset:1024  lds
  buffer_load_dwordx4 v132, s[52:55], s15 offen offset:2048  lds
  buffer_load_dwordx4 v133, s[52:55], s15 offen offset:3072  lds
  buffer_load_dword v1, v2, s[60:63], s101 offen sc1
  s_waitcnt vmcnt(33)
  v_add_u32 v4, s16, v134
  v_add_u32 v5, s16, v135
  v_add_u32 v6, s16, v136
  v_add_u32 v7, s16, v137
  ds_read_b64_tr_b16 v[236:237], v4 offset:0
  ds_read_b64_tr_b16 v[238:239], v4 offset:2048
  ds_read_b64_tr_b16 v[240:241], v5 offset:0
  ds_read_b64_tr_b16 v[242:243], v5 offset:2048
  ds_read_b64_tr_b16 v[244:245], v6 offset:0
  ds_read_b64_tr_b16 v[246:247], v6 offset:2048
  ds_read_b64_tr_b16 v[248:249], v7 offset:0
  ds_read_b64_tr_b16 v[250:251], v7 offset:2048
  s_waitcnt lgkmcnt(8)
  s_mov_b32 m0, s11
  s_add_u32 s15, s14, 4
  s_and_b32 s15, s15, 7
  s_or_b32 s15, s15, 24
  s_lshl_b32 s15, s15, 16
  s_add_u32 s15, s15, s9
  buffer_load_dwordx4 v130, s[52:55], s15 offen offset:0  lds
  buffer_load_dwordx4 v131, s[52:55], s15 offen offset:1024  lds
  buffer_load_dwordx4 v132, s[52:55], s15 offen offset:2048  lds
  buffer_load_dwordx4 v133, s[52:55], s15 offen offset:3072  lds
  s_waitcnt lgkmcnt(0)
  s_mov_b32 m0, s16
  s_add_u32 s15, s14, 5
  s_and_b32 s15, s15, 7
  s_or_b32 s15, s15, 24
  s_lshl_b32 s15, s15, 16
  s_add_u32 s15, s15, s9
  buffer_load_dwordx4 v130, s[52:55], s15 offen offset:0  lds
  buffer_load_dwordx4 v131, s[52:55], s15 offen offset:1024  lds
  buffer_load_dwordx4 v132, s[52:55], s15 offen offset:2048  lds
  buffer_load_dwordx4 v133, s[52:55], s15 offen offset:3072  lds
  s_waitcnt vmcnt(8)
  v_readfirstlane_b32 s4, v1
  s_nop 3
  s_cmp_ge_u32 s4, 8
  s_cbranch_scc1 L_polldone_ached__near_ridge_kernel
  s_mov_b32 s5, 0
L_poll_ached__near_ridge_kernel:
  buffer_load_dword v1, v2, s[60:63], s101 offen sc1
  s_waitcnt vmcnt(0)
  v_readfirstlane_b32 s4, v1
  s_add_u32 s5, s5, 1
  s_cmp_gt_u32 s5, 0x40000
  s_cbranch_scc1 L_polldone_ached__near_ridge_kernel
  s_nop 0
  s_cmp_lt_u32 s4, 8
  s_cbranch_scc1 L_poll_ached__near_ridge_kernel
L_polldone_ached__near_ridge_kernel:
  s_add_u32 s70, s14, 0
  s_and_b32 s70, s70, 7
  s_mul_i32 s70, s70, 6144
  s_add_u32 s70, s70, s8
  s_add_u32 s71, s70, 4096
  buffer_load_dwordx4 v[140:143], v124, s[48:51], s70 offen offset:0 sc1
  buffer_load_dwordx4 v[144:147], v124, s[48:51], s70 offen offset:1024 sc1
  buffer_load_dwordx4 v[148:151], v124, s[48:51], s70 offen offset:2048 sc1
  buffer_load_dwordx4 v[152:155], v124, s[48:51], s70 offen offset:3072 sc1
  buffer_load_dwordx4 v[156:159], v124, s[48:51], s71 offen offset:0 sc1
  buffer_load_dwordx4 v[160:163], v124, s[48:51], s71 offen offset:1024 sc1
  s_add_u32 s72, s14, 1
  s_and_b32 s72, s72, 7
  s_mul_i32 s72, s72, 6144
  s_add_u32 s72, s72, s8
  s_add_u32 s73, s72, 4096
  buffer_load_dwordx4 v[164:167], v124, s[48:51], s72 offen offset:0 sc1
  buffer_load_dwordx4 v[168:171], v124, s[48:51], s72 offen offset:1024 sc1
  buffer_load_dwordx4 v[172:175], v124, s[48:51], s72 offen offset:2048 sc1
  buffer_load_dwordx4 v[176:179], v124, s[48:51], s72 offen offset:3072 sc1
  buffer_load_dwordx4 v[180:183], v124, s[48:51], s73 offen offset:0 sc1
  buffer_load_dwordx4 v[184:187], v124, s[48:51], s73 offen offset:1024 sc1
  v_lshrrev_b32 v1, 3, v0
  v_lshrrev_b32 v2, 4, v0
  v_and_b32 v3, 15, v0
  v_and_b32 v4, 7, v0
  s_mul_i32 s4, s3, 26112
  v_mul_u32_u24 v5, 272, v3
  v_lshl_add_u32 v5, v2, 4, v5
  v_add_u32 v104, s4, v5
  s_mul_i32 s4, s3, 6528
  v_mul_u32_u24 v5, 272, v1
  v_lshl_add_u32 v5, v4, 5, v5
  v_add_u32 v105, s4, v5
  v_add_u32 v106, 52224, v105
  v_lshlrev_b32 v5, 12, v1
  v_lshl_add_u32 v107, v4, 4, v5
  s_mul_i32 s78, s18, 393216
  s_lshl_b32 s4, s26, 11
  s_add_u32 s78, s78, s4
  s_lshl_b32 s4, s19, 7
  s_add_u32 s78, s78, s4
  s_mul_i32 s4, s3, 98304
  s_add_u32 s78, s78, s4
  s_waitcnt vmcnt(11)
  v_mfma_f32_16x16x32_bf16 v[8:11], a[48:51], v[140:143], 0
  s_add_u32 s70, s14, 2
  s_and_b32 s70, s70, 7
  v_mfma_f32_16x16x32_bf16 v[12:15], a[52:55], v[140:143], 0
  s_mul_i32 s70, s70, 6144
  s_add_u32 s70, s70, s8
  v_mfma_f32_16x16x32_bf16 v[16:19], a[56:59], v[140:143], 0
  s_add_u32 s71, s70, 4096
  v_mfma_f32_16x16x32_bf16 v[20:23], a[60:63], v[140:143], 0
  buffer_load_dwordx4 v[140:143], v124, s[48:51], s70 offen offset:0 sc1
  s_waitcnt vmcnt(11)
  v_mfma_f32_16x16x32_bf16 v[24:27], a[48:51], v[144:147], 0
  v_mfma_f32_16x16x32_bf16 v[28:31], a[52:55], v[144:147], 0
  v_mfma_f32_16x16x32_bf16 v[32:35], a[56:59], v[144:147], 0
  v_mfma_f32_16x16x32_bf16 v[36:39], a[60:63], v[144:147], 0
  buffer_load_dwordx4 v[144:147], v124, s[48:51], s70 offen offset:1024 sc1
  s_waitcnt vmcnt(11)
  v_mfma_f32_16x16x32_bf16 v[40:43], a[48:51], v[148:151], 0
  v_mfma_f32_16x16x32_bf16 v[44:47], a[52:55], v[148:151], 0
  v_mfma_f32_16x16x32_bf16 v[48:51], a[56:59], v[148:151], 0
  v_mfma_f32_16x16x32_bf16 v[52:55], a[60:63], v[148:151], 0
  buffer_load_dwordx4 v[148:151], v124, s[48:51], s70 offen offset:2048 sc1
  s_waitcnt vmcnt(11)
  v_mfma_f32_16x16x32_bf16 v[56:59], a[48:51], v[152:155], 0
  v_mfma_f32_16x16x32_bf16 v[60:63], a[52:55], v[152:155], 0
  v_mfma_f32_16x16x32_bf16 v[64:67], a[56:59], v[152:155], 0
  v_mfma_f32_16x16x32_bf16 v[68:71], a[60:63], v[152:155], 0
  buffer_load_dwordx4 v[152:155], v124, s[48:51], s70 offen offset:3072 sc1
  s_waitcnt vmcnt(11)
  v_mfma_f32_16x16x32_bf16 v[72:75], a[48:51], v[156:159], 0
  v_mfma_f32_16x16x32_bf16 v[76:79], a[52:55], v[156:159], 0
  v_mfma_f32_16x16x32_bf16 v[80:83], a[56:59], v[156:159], 0
  v_mfma_f32_16x16x32_bf16 v[84:87], a[60:63], v[156:159], 0
  buffer_load_dwordx4 v[156:159], v124, s[48:51], s71 offen offset:0 sc1
  s_waitcnt vmcnt(11)
  v_mfma_f32_16x16x32_bf16 v[88:91], a[48:51], v[160:163], 0
  v_mfma_f32_16x16x32_bf16 v[92:95], a[52:55], v[160:163], 0
  v_mfma_f32_16x16x32_bf16 v[96:99], a[56:59], v[160:163], 0
  v_mfma_f32_16x16x32_bf16 v[100:103], a[60:63], v[160:163], 0
  buffer_load_dwordx4 v[160:163], v124, s[48:51], s71 offen offset:1024 sc1
  s_waitcnt vmcnt(11)
  v_mfma_f32_16x16x32_bf16 v[8:11], a[64:67], v[164:167], v[8:11]
  s_add_u32 s72, s14, 3
  s_and_b32 s72, s72, 7
  v_mfma_f32_16x16x32_bf16 v[12:15], a[68:71], v[164:167], v[12:15]
  s_mul_i32 s72, s72, 6144
  s_add_u32 s72, s72, s8
  v_mfma_f32_16x16x32_bf16 v[16:19], a[72:75], v[164:167], v[16:19]
  s_add_u32 s73, s72, 4096
  v_mfma_f32_16x16x32_bf16 v[20:23], a[76:79], v[164:167], v[20:23]
  buffer_load_dwordx4 v[164:167], v124, s[48:51], s72 offen offset:0 sc1
  s_waitcnt vmcnt(11)
  v_mfma_f32_16x16x32_bf16 v[24:27], a[64:67], v[168:171], v[24:27]
  v_mfma_f32_16x16x32_bf16 v[28:31], a[68:71], v[168:171], v[28:31]
  v_mfma_f32_16x16x32_bf16 v[32:35], a[72:75], v[168:171], v[32:35]
  v_mfma_f32_16x16x32_bf16 v[36:39], a[76:79], v[168:171], v[36:39]
  buffer_load_dwordx4 v[168:171], v124, s[48:51], s72 offen offset:1024 sc1
  s_waitcnt vmcnt(11)
  v_mfma_f32_16x16x32_bf16 v[40:43], a[64:67], v[172:175], v[40:43]
  v_mfma_f32_16x16x32_bf16 v[44:47], a[68:71], v[172:175], v[44:47]
  v_mfma_f32_16x16x32_bf16 v[48:51], a[72:75], v[172:175], v[48:51]
  v_mfma_f32_16x16x32_bf16 v[52:55], a[76:79], v[172:175], v[52:55]
  buffer_load_dwordx4 v[172:175], v124, s[48:51], s72 offen offset:2048 sc1
  s_waitcnt vmcnt(11)
  v_mfma_f32_16x16x32_bf16 v[56:59], a[64:67], v[176:179], v[56:59]
  v_mfma_f32_16x16x32_bf16 v[60:63], a[68:71], v[176:179], v[60:63]
  v_mfma_f32_16x16x32_bf16 v[64:67], a[72:75], v[176:179], v[64:67]
  v_mfma_f32_16x16x32_bf16 v[68:71], a[76:79], v[176:179], v[68:71]
  buffer_load_dwordx4 v[176:179], v124, s[48:51], s72 offen offset:3072 sc1
  s_waitcnt vmcnt(11)
  v_mfma_f32_16x16x32_bf16 v[72:75], a[64:67], v[180:183], v[72:75]
  v_mfma_f32_16x16x32_bf16 v[76:79], a[68:71], v[180:183], v[76:79]
  v_mfma_f32_16x16x32_bf16 v[80:83], a[72:75], v[180:183], v[80:83]
  v_mfma_f32_16x16x32_bf16 v[84:87], a[76:79], v[180:183], v[84:87]
  buffer_load_dwordx4 v[180:183], v124, s[48:51], s73 offen offset:0 sc1
  s_waitcnt vmcnt(11)
  v_mfma_f32_16x16x32_bf16 v[88:91], a[64:67], v[184:187], v[88:91]
  v_mfma_f32_16x16x32_bf16 v[92:95], a[68:71], v[184:187], v[92:95]
  v_mfma_f32_16x16x32_bf16 v[96:99], a[72:75], v[184:187], v[96:99]
  v_mfma_f32_16x16x32_bf16 v[100:103], a[76:79], v[184:187], v[100:103]
  buffer_load_dwordx4 v[184:187], v124, s[48:51], s73 offen offset:1024 sc1
  s_waitcnt vmcnt(11)
  v_mfma_f32_16x16x32_bf16 v[8:11], a[80:83], v[140:143], v[8:11]
  s_add_u32 s70, s14, 4
  s_and_b32 s70, s70, 7
  v_mfma_f32_16x16x32_bf16 v[12:15], a[84:87], v[140:143], v[12:15]
  s_mul_i32 s70, s70, 6144
  s_add_u32 s70, s70, s8
  v_mfma_f32_16x16x32_bf16 v[16:19], a[88:91], v[140:143], v[16:19]
  s_add_u32 s71, s70, 4096
  v_mfma_f32_16x16x32_bf16 v[20:23], a[92:95], v[140:143], v[20:23]
  buffer_load_dwordx4 v[140:143], v124, s[48:51], s70 offen offset:0 sc1
  s_waitcnt vmcnt(11)
  v_mfma_f32_16x16x32_bf16 v[24:27], a[80:83], v[144:147], v[24:27]
  v_mfma_f32_16x16x32_bf16 v[28:31], a[84:87], v[144:147], v[28:31]
  v_mfma_f32_16x16x32_bf16 v[32:35], a[88:91], v[144:147], v[32:35]
  v_mfma_f32_16x16x32_bf16 v[36:39], a[92:95], v[144:147], v[36:39]
  buffer_load_dwordx4 v[144:147], v124, s[48:51], s70 offen offset:1024 sc1
  s_waitcnt vmcnt(11)
  v_mfma_f32_16x16x32_bf16 v[40:43], a[80:83], v[148:151], v[40:43]
  v_mfma_f32_16x16x32_bf16 v[44:47], a[84:87], v[148:151], v[44:47]
  v_mfma_f32_16x16x32_bf16 v[48:51], a[88:91], v[148:151], v[48:51]
  v_mfma_f32_16x16x32_bf16 v[52:55], a[92:95], v[148:151], v[52:55]
  buffer_load_dwordx4 v[148:151], v124, s[48:51], s70 offen offset:2048 sc1
  s_waitcnt vmcnt(11)
  v_mfma_f32_16x16x32_bf16 v[56:59], a[80:83], v[152:155], v[56:59]
  v_mfma_f32_16x16x32_bf16 v[60:63], a[84:87], v[152:155], v[60:63]
  v_mfma_f32_16x16x32_bf16 v[64:67], a[88:91], v[152:155], v[64:67]
  v_mfma_f32_16x16x32_bf16 v[68:71], a[92:95], v[152:155], v[68:71]
  buffer_load_dwordx4 v[152:155], v124, s[48:51], s70 offen offset:3072 sc1
  s_waitcnt vmcnt(11)
  v_mfma_f32_16x16x32_bf16 v[72:75], a[80:83], v[156:159], v[72:75]
  v_mfma_f32_16x16x32_bf16 v[76:79], a[84:87], v[156:159], v[76:79]
  v_mfma_f32_16x16x32_bf16 v[80:83], a[88:91], v[156:159], v[80:83]
  v_mfma_f32_16x16x32_bf16 v[84:87], a[92:95], v[156:159], v[84:87]
  buffer_load_dwordx4 v[156:159], v124, s[48:51], s71 offen offset:0 sc1
  s_waitcnt vmcnt(11)
  v_mfma_f32_16x16x32_bf16 v[88:91], a[80:83], v[160:163], v[88:91]
  v_mfma_f32_16x16x32_bf16 v[92:95], a[84:87], v[160:163], v[92:95]
  v_mfma_f32_16x16x32_bf16 v[96:99], a[88:91], v[160:163], v[96:99]
  v_mfma_f32_16x16x32_bf16 v[100:103], a[92:95], v[160:163], v[100:103]
  buffer_load_dwordx4 v[160:163], v124, s[48:51], s71 offen offset:1024 sc1
  s_waitcnt vmcnt(11)
  v_mfma_f32_16x16x32_bf16 v[8:11], a[96:99], v[164:167], v[8:11]
  s_add_u32 s72, s14, 5
  s_and_b32 s72, s72, 7
  v_mfma_f32_16x16x32_bf16 v[12:15], a[100:103], v[164:167], v[12:15]
  s_mul_i32 s72, s72, 6144
  s_add_u32 s72, s72, s8
  v_mfma_f32_16x16x32_bf16 v[16:19], a[104:107], v[164:167], v[16:19]
  s_add_u32 s73, s72, 4096
  v_mfma_f32_16x16x32_bf16 v[20:23], a[108:111], v[164:167], v[20:23]
  buffer_load_dwordx4 v[164:167], v124, s[48:51], s72 offen offset:0 sc1
  s_waitcnt vmcnt(11)
  v_mfma_f32_16x16x32_bf16 v[24:27], a[96:99], v[168:171], v[24:27]
  v_mfma_f32_16x16x32_bf16 v[28:31], a[100:103], v[168:171], v[28:31]
  v_mfma_f32_16x16x32_bf16 v[32:35], a[104:107], v[168:171], v[32:35]
  v_mfma_f32_16x16x32_bf16 v[36:39], a[108:111], v[168:171], v[36:39]
  buffer_load_dwordx4 v[168:171], v124, s[48:51], s72 offen offset:1024 sc1
  s_waitcnt vmcnt(11)
  v_mfma_f32_16x16x32_bf16 v[40:43], a[96:99], v[172:175], v[40:43]
  v_mfma_f32_16x16x32_bf16 v[44:47], a[100:103], v[172:175], v[44:47]
  v_mfma_f32_16x16x32_bf16 v[48:51], a[104:107], v[172:175], v[48:51]
  v_mfma_f32_16x16x32_bf16 v[52:55], a[108:111], v[172:175], v[52:55]
  buffer_load_dwordx4 v[172:175], v124, s[48:51], s72 offen offset:2048 sc1
  s_waitcnt vmcnt(11)
  v_mfma_f32_16x16x32_bf16 v[56:59], a[96:99], v[176:179], v[56:59]
  v_mfma_f32_16x16x32_bf16 v[60:63], a[100:103], v[176:179], v[60:63]
  v_mfma_f32_16x16x32_bf16 v[64:67], a[104:107], v[176:179], v[64:67]
  v_mfma_f32_16x16x32_bf16 v[68:71], a[108:111], v[176:179], v[68:71]
  buffer_load_dwordx4 v[176:179], v124, s[48:51], s72 offen offset:3072 sc1
  s_waitcnt vmcnt(11)
  v_mfma_f32_16x16x32_bf16 v[72:75], a[96:99], v[180:183], v[72:75]
  v_mfma_f32_16x16x32_bf16 v[76:79], a[100:103], v[180:183], v[76:79]
  v_mfma_f32_16x16x32_bf16 v[80:83], a[104:107], v[180:183], v[80:83]
  v_mfma_f32_16x16x32_bf16 v[84:87], a[108:111], v[180:183], v[84:87]
  buffer_load_dwordx4 v[180:183], v124, s[48:51], s73 offen offset:0 sc1
  s_waitcnt vmcnt(11)
  v_mfma_f32_16x16x32_bf16 v[88:91], a[96:99], v[184:187], v[88:91]
  v_mfma_f32_16x16x32_bf16 v[92:95], a[100:103], v[184:187], v[92:95]
  v_mfma_f32_16x16x32_bf16 v[96:99], a[104:107], v[184:187], v[96:99]
  v_mfma_f32_16x16x32_bf16 v[100:103], a[108:111], v[184:187], v[100:103]
  buffer_load_dwordx4 v[184:187], v124, s[48:51], s73 offen offset:1024 sc1
  s_waitcnt vmcnt(11)
  v_mfma_f32_16x16x32_bf16 v[8:11], a[112:115], v[140:143], v[8:11]
  s_add_u32 s70, s14, 6
  s_and_b32 s70, s70, 7
  v_mfma_f32_16x16x32_bf16 v[12:15], a[116:119], v[140:143], v[12:15]
  s_mul_i32 s70, s70, 6144
  s_add_u32 s70, s70, s8
  v_mfma_f32_16x16x32_bf16 v[16:19], a[120:123], v[140:143], v[16:19]
  s_add_u32 s71, s70, 4096
  v_mfma_f32_16x16x32_bf16 v[20:23], a[124:127], v[140:143], v[20:23]
  buffer_load_dwordx4 v[140:143], v124, s[48:51], s70 offen offset:0 sc1
  s_waitcnt vmcnt(11)
  v_mfma_f32_16x16x32_bf16 v[24:27], a[112:115], v[144:147], v[24:27]
  v_mfma_f32_16x16x32_bf16 v[28:31], a[116:119], v[144:147], v[28:31]
  v_mfma_f32_16x16x32_bf16 v[32:35], a[120:123], v[144:147], v[32:35]
  v_mfma_f32_16x16x32_bf16 v[36:39], a[124:127], v[144:147], v[36:39]
  buffer_load_dwordx4 v[144:147], v124, s[48:51], s70 offen offset:1024 sc1
  s_waitcnt vmcnt(11)
  v_mfma_f32_16x16x32_bf16 v[40:43], a[112:115], v[148:151], v[40:43]
  v_mfma_f32_16x16x32_bf16 v[44:47], a[116:119], v[148:151], v[44:47]
  v_mfma_f32_16x16x32_bf16 v[48:51], a[120:123], v[148:151], v[48:51]
  v_mfma_f32_16x16x32_bf16 v[52:55], a[124:127], v[148:151], v[52:55]
  buffer_load_dwordx4 v[148:151], v124, s[48:51], s70 offen offset:2048 sc1
  s_waitcnt vmcnt(11)
  v_mfma_f32_16x16x32_bf16 v[56:59], a[112:115], v[152:155], v[56:59]
  v_mfma_f32_16x16x32_bf16 v[60:63], a[116:119], v[152:155], v[60:63]
  v_mfma_f32_16x16x32_bf16 v[64:67], a[120:123], v[152:155], v[64:67]
  v_mfma_f32_16x16x32_bf16 v[68:71], a[124:127], v[152:155], v[68:71]
  buffer_load_dwordx4 v[152:155], v124, s[48:51], s70 offen offset:3072 sc1
  s_waitcnt vmcnt(11)
  v_mfma_f32_16x16x32_bf16 v[72:75], a[112:115], v[156:159], v[72:75]
  v_mfma_f32_16x16x32_bf16 v[76:79], a[116:119], v[156:159], v[76:79]
  v_mfma_f32_16x16x32_bf16 v[80:83], a[120:123], v[156:159], v[80:83]
  v_mfma_f32_16x16x32_bf16 v[84:87], a[124:127], v[156:159], v[84:87]
  buffer_load_dwordx4 v[156:159], v124, s[48:51], s71 offen offset:0 sc1
  s_waitcnt vmcnt(11)
  v_mfma_f32_16x16x32_bf16 v[88:91], a[112:115], v[160:163], v[88:91]
  v_mfma_f32_16x16x32_bf16 v[92:95], a[116:119], v[160:163], v[92:95]
  v_mfma_f32_16x16x32_bf16 v[96:99], a[120:123], v[160:163], v[96:99]
  v_mfma_f32_16x16x32_bf16 v[100:103], a[124:127], v[160:163], v[100:103]
  buffer_load_dwordx4 v[160:163], v124, s[48:51], s71 offen offset:1024 sc1
  s_waitcnt vmcnt(11)
  v_mfma_f32_16x16x32_bf16 v[8:11], a[128:131], v[164:167], v[8:11]
  s_add_u32 s72, s14, 7
  s_and_b32 s72, s72, 7
  v_mfma_f32_16x16x32_bf16 v[12:15], a[132:135], v[164:167], v[12:15]
  s_mul_i32 s72, s72, 6144
  s_add_u32 s72, s72, s8
  v_mfma_f32_16x16x32_bf16 v[16:19], a[136:139], v[164:167], v[16:19]
  s_add_u32 s73, s72, 4096
  v_mfma_f32_16x16x32_bf16 v[20:23], a[140:143], v[164:167], v[20:23]
  buffer_load_dwordx4 v[164:167], v124, s[48:51], s72 offen offset:0 sc1
  s_waitcnt vmcnt(11)
  v_mfma_f32_16x16x32_bf16 v[24:27], a[128:131], v[168:171], v[24:27]
  v_mfma_f32_16x16x32_bf16 v[28:31], a[132:135], v[168:171], v[28:31]
  v_mfma_f32_16x16x32_bf16 v[32:35], a[136:139], v[168:171], v[32:35]
  v_mfma_f32_16x16x32_bf16 v[36:39], a[140:143], v[168:171], v[36:39]
  buffer_load_dwordx4 v[168:171], v124, s[48:51], s72 offen offset:1024 sc1
  s_waitcnt vmcnt(11)
  v_mfma_f32_16x16x32_bf16 v[40:43], a[128:131], v[172:175], v[40:43]
  v_mfma_f32_16x16x32_bf16 v[44:47], a[132:135], v[172:175], v[44:47]
  v_mfma_f32_16x16x32_bf16 v[48:51], a[136:139], v[172:175], v[48:51]
  v_mfma_f32_16x16x32_bf16 v[52:55], a[140:143], v[172:175], v[52:55]
  buffer_load_dwordx4 v[172:175], v124, s[48:51], s72 offen offset:2048 sc1
  s_waitcnt vmcnt(11)
  v_mfma_f32_16x16x32_bf16 v[56:59], a[128:131], v[176:179], v[56:59]
  v_mfma_f32_16x16x32_bf16 v[60:63], a[132:135], v[176:179], v[60:63]
  v_mfma_f32_16x16x32_bf16 v[64:67], a[136:139], v[176:179], v[64:67]
  v_mfma_f32_16x16x32_bf16 v[68:71], a[140:143], v[176:179], v[68:71]
  buffer_load_dwordx4 v[176:179], v124, s[48:51], s72 offen offset:3072 sc1
  s_waitcnt vmcnt(11)
  v_mfma_f32_16x16x32_bf16 v[72:75], a[128:131], v[180:183], v[72:75]
  v_mfma_f32_16x16x32_bf16 v[76:79], a[132:135], v[180:183], v[76:79]
  v_mfma_f32_16x16x32_bf16 v[80:83], a[136:139], v[180:183], v[80:83]
  v_mfma_f32_16x16x32_bf16 v[84:87], a[140:143], v[180:183], v[84:87]
  buffer_load_dwordx4 v[180:183], v124, s[48:51], s73 offen offset:0 sc1
  s_waitcnt vmcnt(11)
  v_mfma_f32_16x16x32_bf16 v[88:91], a[128:131], v[184:187], v[88:91]
  v_mfma_f32_16x16x32_bf16 v[92:95], a[132:135], v[184:187], v[92:95]
  v_mfma_f32_16x16x32_bf16 v[96:99], a[136:139], v[184:187], v[96:99]
  v_mfma_f32_16x16x32_bf16 v[100:103], a[140:143], v[184:187], v[100:103]
  buffer_load_dwordx4 v[184:187], v124, s[48:51], s73 offen offset:1024 sc1
  s_waitcnt vmcnt(11)
  v_mfma_f32_16x16x32_bf16 v[8:11], a[144:147], v[140:143], v[8:11]
  s_add_u32 s70, s14, 0
  s_and_b32 s70, s70, 7
  v_mfma_f32_16x16x32_bf16 v[12:15], a[148:151], v[140:143], v[12:15]
  s_or_b32 s70, s70, 8
  s_mul_i32 s70, s70, 6144
  v_mfma_f32_16x16x32_bf16 v[16:19], a[152:155], v[140:143], v[16:19]
  s_add_u32 s70, s70, s8
  s_add_u32 s71, s70, 4096
  v_mfma_f32_16x16x32_bf16 v[20:23], a[156:159], v[140:143], v[20:23]
  buffer_load_dwordx4 v[140:143], v124, s[48:51], s70 offen offset:0 sc1
  s_waitcnt vmcnt(11)
  v_mfma_f32_16x16x32_bf16 v[24:27], a[144:147], v[144:147], v[24:27]
  v_mfma_f32_16x16x32_bf16 v[28:31], a[148:151], v[144:147], v[28:31]
  v_mfma_f32_16x16x32_bf16 v[32:35], a[152:155], v[144:147], v[32:35]
  v_mfma_f32_16x16x32_bf16 v[36:39], a[156:159], v[144:147], v[36:39]
  buffer_load_dwordx4 v[144:147], v124, s[48:51], s70 offen offset:1024 sc1
  s_waitcnt vmcnt(11)
  v_mfma_f32_16x16x32_bf16 v[40:43], a[144:147], v[148:151], v[40:43]
  v_mfma_f32_16x16x32_bf16 v[44:47], a[148:151], v[148:151], v[44:47]
  v_mfma_f32_16x16x32_bf16 v[48:51], a[152:155], v[148:151], v[48:51]
  v_mfma_f32_16x16x32_bf16 v[52:55], a[156:159], v[148:151], v[52:55]
  buffer_load_dwordx4 v[148:151], v124, s[48:51], s70 offen offset:2048 sc1
  s_waitcnt vmcnt(11)
  v_mfma_f32_16x16x32_bf16 v[56:59], a[144:147], v[152:155], v[56:59]
  v_mfma_f32_16x16x32_bf16 v[60:63], a[148:151], v[152:155], v[60:63]
  v_mfma_f32_16x16x32_bf16 v[64:67], a[152:155], v[152:155], v[64:67]
  v_mfma_f32_16x16x32_bf16 v[68:71], a[156:159], v[152:155], v[68:71]
  buffer_load_dwordx4 v[152:155], v124, s[48:51], s70 offen offset:3072 sc1
  s_waitcnt vmcnt(11)
  v_mfma_f32_16x16x32_bf16 v[72:75], a[144:147], v[156:159], v[72:75]
  v_mfma_f32_16x16x32_bf16 v[76:79], a[148:151], v[156:159], v[76:79]
  v_mfma_f32_16x16x32_bf16 v[80:83], a[152:155], v[156:159], v[80:83]
  v_mfma_f32_16x16x32_bf16 v[84:87], a[156:159], v[156:159], v[84:87]
  buffer_load_dwordx4 v[156:159], v124, s[48:51], s71 offen offset:0 sc1
  s_waitcnt vmcnt(11)
  v_mfma_f32_16x16x32_bf16 v[88:91], a[144:147], v[160:163], v[88:91]
  v_mfma_f32_16x16x32_bf16 v[92:95], a[148:151], v[160:163], v[92:95]
  v_mfma_f32_16x16x32_bf16 v[96:99], a[152:155], v[160:163], v[96:99]
  v_mfma_f32_16x16x32_bf16 v[100:103], a[156:159], v[160:163], v[100:103]
  buffer_load_dwordx4 v[160:163], v124, s[48:51], s71 offen offset:1024 sc1
  s_waitcnt vmcnt(11)
  v_mfma_f32_16x16x32_bf16 v[8:11], a[160:163], v[164:167], v[8:11]
  s_add_u32 s72, s14, 1
  s_and_b32 s72, s72, 7
  v_mfma_f32_16x16x32_bf16 v[12:15], a[164:167], v[164:167], v[12:15]
  s_or_b32 s72, s72, 8
  s_mul_i32 s72, s72, 6144
  v_mfma_f32_16x16x32_bf16 v[16:19], a[168:171], v[164:167], v[16:19]
  s_add_u32 s72, s72, s8
  s_add_u32 s73, s72, 4096
  v_mfma_f32_16x16x32_bf16 v[20:23], a[172:175], v[164:167], v[20:23]
  buffer_load_dwordx4 v[164:167], v124, s[48:51], s72 offen offset:0 sc1
  s_waitcnt vmcnt(11)
  v_mfma_f32_16x16x32_bf16 v[24:27], a[160:163], v[168:171], v[24:27]
  v_mfma_f32_16x16x32_bf16 v[28:31], a[164:167], v[168:171], v[28:31]
  v_mfma_f32_16x16x32_bf16 v[32:35], a[168:171], v[168:171], v[32:35]
  v_mfma_f32_16x16x32_bf16 v[36:39], a[172:175], v[168:171], v[36:39]
  buffer_load_dwordx4 v[168:171], v124, s[48:51], s72 offen offset:1024 sc1
  s_waitcnt vmcnt(11)
  v_mfma_f32_16x16x32_bf16 v[40:43], a[160:163], v[172:175], v[40:43]
  v_mfma_f32_16x16x32_bf16 v[44:47], a[164:167], v[172:175], v[44:47]
  v_mfma_f32_16x16x32_bf16 v[48:51], a[168:171], v[172:175], v[48:51]
  v_mfma_f32_16x16x32_bf16 v[52:55], a[172:175], v[172:175], v[52:55]
  buffer_load_dwordx4 v[172:175], v124, s[48:51], s72 offen offset:2048 sc1
  s_waitcnt vmcnt(11)
  v_mfma_f32_16x16x32_bf16 v[56:59], a[160:163], v[176:179], v[56:59]
  v_mfma_f32_16x16x32_bf16 v[60:63], a[164:167], v[176:179], v[60:63]
  v_mfma_f32_16x16x32_bf16 v[64:67], a[168:171], v[176:179], v[64:67]
  v_mfma_f32_16x16x32_bf16 v[68:71], a[172:175], v[176:179], v[68:71]
  buffer_load_dwordx4 v[176:179], v124, s[48:51], s72 offen offset:3072 sc1
  s_waitcnt vmcnt(11)
  v_mfma_f32_16x16x32_bf16 v[72:75], a[160:163], v[180:183], v[72:75]
  v_mfma_f32_16x16x32_bf16 v[76:79], a[164:167], v[180:183], v[76:79]
  v_mfma_f32_16x16x32_bf16 v[80:83], a[168:171], v[180:183], v[80:83]
  v_mfma_f32_16x16x32_bf16 v[84:87], a[172:175], v[180:183], v[84:87]
  buffer_load_dwordx4 v[180:183], v124, s[48:51], s73 offen offset:0 sc1
  s_waitcnt vmcnt(11)
  v_mfma_f32_16x16x32_bf16 v[88:91], a[160:163], v[184:187], v[88:91]
  v_mfma_f32_16x16x32_bf16 v[92:95], a[164:167], v[184:187], v[92:95]
  v_mfma_f32_16x16x32_bf16 v[96:99], a[168:171], v[184:187], v[96:99]
  v_mfma_f32_16x16x32_bf16 v[100:103], a[172:175], v[184:187], v[100:103]
  buffer_load_dwordx4 v[184:187], v124, s[48:51], s73 offen offset:1024 sc1
  s_waitcnt vmcnt(11)
  v_mfma_f32_16x16x32_bf16 v[8:11], a[176:179], v[140:143], v[8:11]
  s_add_u32 s70, s14, 2
  s_and_b32 s70, s70, 7
  v_mfma_f32_16x16x32_bf16 v[12:15], a[180:183], v[140:143], v[12:15]
  s_or_b32 s70, s70, 8
  s_mul_i32 s70, s70, 6144
  v_mfma_f32_16x16x32_bf16 v[16:19], a[232:235], v[140:143], v[16:19]
  s_add_u32 s70, s70, s8
  s_add_u32 s71, s70, 4096
  v_mfma_f32_16x16x32_bf16 v[20:23], a[236:239], v[140:143], v[20:23]
  buffer_load_dwordx4 v[140:143], v124, s[48:51], s70 offen offset:0 sc1
  s_waitcnt vmcnt(11)
  v_mfma_f32_16x16x32_bf16 v[24:27], a[176:179], v[144:147], v[24:27]
  v_mfma_f32_16x16x32_bf16 v[28:31], a[180:183], v[144:147], v[28:31]
  v_mfma_f32_16x16x32_bf16 v[32:35], a[232:235], v[144:147], v[32:35]
  v_mfma_f32_16x16x32_bf16 v[36:39], a[236:239], v[144:147], v[36:39]
  buffer_load_dwordx4 v[144:147], v124, s[48:51], s70 offen offset:1024 sc1
  s_waitcnt vmcnt(11)
  v_mfma_f32_16x16x32_bf16 v[40:43], a[176:179], v[148:151], v[40:43]
  v_mfma_f32_16x16x32_bf16 v[44:47], a[180:183], v[148:151], v[44:47]
  v_mfma_f32_16x16x32_bf16 v[48:51], a[232:235], v[148:151], v[48:51]
  v_mfma_f32_16x16x32_bf16 v[52:55], a[236:239], v[148:151], v[52:55]
  buffer_load_dwordx4 v[148:151], v124, s[48:51], s70 offen offset:2048 sc1
  s_waitcnt vmcnt(11)
  v_mfma_f32_16x16x32_bf16 v[56:59], a[176:179], v[152:155], v[56:59]
  v_mfma_f32_16x16x32_bf16 v[60:63], a[180:183], v[152:155], v[60:63]
  v_mfma_f32_16x16x32_bf16 v[64:67], a[232:235], v[152:155], v[64:67]
  v_mfma_f32_16x16x32_bf16 v[68:71], a[236:239], v[152:155], v[68:71]
  buffer_load_dwordx4 v[152:155], v124, s[48:51], s70 offen offset:3072 sc1
  s_waitcnt vmcnt(11)
  v_mfma_f32_16x16x32_bf16 v[72:75], a[176:179], v[156:159], v[72:75]
  v_mfma_f32_16x16x32_bf16 v[76:79], a[180:183], v[156:159], v[76:79]
  v_mfma_f32_16x16x32_bf16 v[80:83], a[232:235], v[156:159], v[80:83]
  v_mfma_f32_16x16x32_bf16 v[84:87], a[236:239], v[156:159], v[84:87]
  buffer_load_dwordx4 v[156:159], v124, s[48:51], s71 offen offset:0 sc1
  s_waitcnt vmcnt(11)
  v_mfma_f32_16x16x32_bf16 v[88:91], a[176:179], v[160:163], v[88:91]
  v_mfma_f32_16x16x32_bf16 v[92:95], a[180:183], v[160:163], v[92:95]
  v_mfma_f32_16x16x32_bf16 v[96:99], a[232:235], v[160:163], v[96:99]
  v_mfma_f32_16x16x32_bf16 v[100:103], a[236:239], v[160:163], v[100:103]
  buffer_load_dwordx4 v[160:163], v124, s[48:51], s71 offen offset:1024 sc1
  s_waitcnt vmcnt(11)
  v_mfma_f32_16x16x32_bf16 v[8:11], a[240:243], v[164:167], v[8:11]
  s_add_u32 s72, s14, 3
  s_and_b32 s72, s72, 7
  v_mfma_f32_16x16x32_bf16 v[12:15], a[244:247], v[164:167], v[12:15]
  s_or_b32 s72, s72, 8
  s_mul_i32 s72, s72, 6144
  v_mfma_f32_16x16x32_bf16 v[16:19], a[248:251], v[164:167], v[16:19]
  s_add_u32 s72, s72, s8
  s_add_u32 s73, s72, 4096
  v_mfma_f32_16x16x32_bf16 v[20:23], a[252:255], v[164:167], v[20:23]
  buffer_load_dwordx4 v[164:167], v124, s[48:51], s72 offen offset:0 sc1
  s_waitcnt vmcnt(11)
  v_mfma_f32_16x16x32_bf16 v[24:27], a[240:243], v[168:171], v[24:27]
  v_mfma_f32_16x16x32_bf16 v[28:31], a[244:247], v[168:171], v[28:31]
  v_mfma_f32_16x16x32_bf16 v[32:35], a[248:251], v[168:171], v[32:35]
  v_mfma_f32_16x16x32_bf16 v[36:39], a[252:255], v[168:171], v[36:39]
  buffer_load_dwordx4 v[168:171], v124, s[48:51], s72 offen offset:1024 sc1
  s_waitcnt vmcnt(11)
  v_mfma_f32_16x16x32_bf16 v[40:43], a[240:243], v[172:175], v[40:43]
  v_mfma_f32_16x16x32_bf16 v[44:47], a[244:247], v[172:175], v[44:47]
  v_mfma_f32_16x16x32_bf16 v[48:51], a[248:251], v[172:175], v[48:51]
  v_mfma_f32_16x16x32_bf16 v[52:55], a[252:255], v[172:175], v[52:55]
  buffer_load_dwordx4 v[172:175], v124, s[48:51], s72 offen offset:2048 sc1
  s_waitcnt vmcnt(11)
  v_mfma_f32_16x16x32_bf16 v[56:59], a[240:243], v[176:179], v[56:59]
  v_mfma_f32_16x16x32_bf16 v[60:63], a[244:247], v[176:179], v[60:63]
  v_mfma_f32_16x16x32_bf16 v[64:67], a[248:251], v[176:179], v[64:67]
  v_mfma_f32_16x16x32_bf16 v[68:71], a[252:255], v[176:179], v[68:71]
  buffer_load_dwordx4 v[176:179], v124, s[48:51], s72 offen offset:3072 sc1
  s_waitcnt vmcnt(11)
  v_mfma_f32_16x16x32_bf16 v[72:75], a[240:243], v[180:183], v[72:75]
  v_mfma_f32_16x16x32_bf16 v[76:79], a[244:247], v[180:183], v[76:79]
  v_mfma_f32_16x16x32_bf16 v[80:83], a[248:251], v[180:183], v[80:83]
  v_mfma_f32_16x16x32_bf16 v[84:87], a[252:255], v[180:183], v[84:87]
  buffer_load_dwordx4 v[180:183], v124, s[48:51], s73 offen offset:0 sc1
  s_waitcnt vmcnt(11)
  v_mfma_f32_16x16x32_bf16 v[88:91], a[240:243], v[184:187], v[88:91]
  v_mfma_f32_16x16x32_bf16 v[92:95], a[244:247], v[184:187], v[92:95]
  v_mfma_f32_16x16x32_bf16 v[96:99], a[248:251], v[184:187], v[96:99]
  v_mfma_f32_16x16x32_bf16 v[100:103], a[252:255], v[184:187], v[100:103]
  buffer_load_dwordx4 v[184:187], v124, s[48:51], s73 offen offset:1024 sc1
  s_waitcnt vmcnt(11)
  v_mfma_f32_16x16x32_bf16 v[8:11], a[0:3], v[140:143], v[8:11]
  s_add_u32 s70, s14, 4
  s_and_b32 s70, s70, 7
  v_mfma_f32_16x16x32_bf16 v[12:15], a[4:7], v[140:143], v[12:15]
  s_or_b32 s70, s70, 8
  s_mul_i32 s70, s70, 6144
  v_mfma_f32_16x16x32_bf16 v[16:19], a[8:11], v[140:143], v[16:19]
  s_add_u32 s70, s70, s8
  s_add_u32 s71, s70, 4096
  v_mfma_f32_16x16x32_bf16 v[20:23], a[12:15], v[140:143], v[20:23]
  buffer_load_dwordx4 v[140:143], v124, s[48:51], s70 offen offset:0 sc1
  s_waitcnt vmcnt(11)
  v_mfma_f32_16x16x32_bf16 v[24:27], a[0:3], v[144:147], v[24:27]
  v_mfma_f32_16x16x32_bf16 v[28:31], a[4:7], v[144:147], v[28:31]
  v_mfma_f32_16x16x32_bf16 v[32:35], a[8:11], v[144:147], v[32:35]
  v_mfma_f32_16x16x32_bf16 v[36:39], a[12:15], v[144:147], v[36:39]
  buffer_load_dwordx4 v[144:147], v124, s[48:51], s70 offen offset:1024 sc1
  s_waitcnt vmcnt(11)
  v_mfma_f32_16x16x32_bf16 v[40:43], a[0:3], v[148:151], v[40:43]
  v_mfma_f32_16x16x32_bf16 v[44:47], a[4:7], v[148:151], v[44:47]
  v_mfma_f32_16x16x32_bf16 v[48:51], a[8:11], v[148:151], v[48:51]
  v_mfma_f32_16x16x32_bf16 v[52:55], a[12:15], v[148:151], v[52:55]
  buffer_load_dwordx4 v[148:151], v124, s[48:51], s70 offen offset:2048 sc1
  s_waitcnt vmcnt(11)
  v_mfma_f32_16x16x32_bf16 v[56:59], a[0:3], v[152:155], v[56:59]
  v_mfma_f32_16x16x32_bf16 v[60:63], a[4:7], v[152:155], v[60:63]
  v_mfma_f32_16x16x32_bf16 v[64:67], a[8:11], v[152:155], v[64:67]
  v_mfma_f32_16x16x32_bf16 v[68:71], a[12:15], v[152:155], v[68:71]
  buffer_load_dwordx4 v[152:155], v124, s[48:51], s70 offen offset:3072 sc1
  s_waitcnt vmcnt(11)
  v_mfma_f32_16x16x32_bf16 v[72:75], a[0:3], v[156:159], v[72:75]
  v_mfma_f32_16x16x32_bf16 v[76:79], a[4:7], v[156:159], v[76:79]
  v_mfma_f32_16x16x32_bf16 v[80:83], a[8:11], v[156:159], v[80:83]
  v_mfma_f32_16x16x32_bf16 v[84:87], a[12:15], v[156:159], v[84:87]
  buffer_load_dwordx4 v[156:159], v124, s[48:51], s71 offen offset:0 sc1
  s_waitcnt vmcnt(11)
  v_mfma_f32_16x16x32_bf16 v[88:91], a[0:3], v[160:163], v[88:91]
  v_mfma_f32_16x16x32_bf16 v[92:95], a[4:7], v[160:163], v[92:95]
  v_mfma_f32_16x16x32_bf16 v[96:99], a[8:11], v[160:163], v[96:99]
  v_mfma_f32_16x16x32_bf16 v[100:103], a[12:15], v[160:163], v[100:103]
  buffer_load_dwordx4 v[160:163], v124, s[48:51], s71 offen offset:1024 sc1
  s_waitcnt vmcnt(11)
  v_mfma_f32_16x16x32_bf16 v[8:11], a[16:19], v[164:167], v[8:11]
  s_add_u32 s72, s14, 5
  s_and_b32 s72, s72, 7
  v_mfma_f32_16x16x32_bf16 v[12:15], a[20:23], v[164:167], v[12:15]
  s_or_b32 s72, s72, 8
  s_mul_i32 s72, s72, 6144
  v_mfma_f32_16x16x32_bf16 v[16:19], a[24:27], v[164:167], v[16:19]
  s_add_u32 s72, s72, s8
  s_add_u32 s73, s72, 4096
  v_mfma_f32_16x16x32_bf16 v[20:23], a[28:31], v[164:167], v[20:23]
  buffer_load_dwordx4 v[164:167], v124, s[48:51], s72 offen offset:0 sc1
  s_waitcnt vmcnt(11)
  v_mfma_f32_16x16x32_bf16 v[24:27], a[16:19], v[168:171], v[24:27]
  v_mfma_f32_16x16x32_bf16 v[28:31], a[20:23], v[168:171], v[28:31]
  v_mfma_f32_16x16x32_bf16 v[32:35], a[24:27], v[168:171], v[32:35]
  v_mfma_f32_16x16x32_bf16 v[36:39], a[28:31], v[168:171], v[36:39]
  buffer_load_dwordx4 v[168:171], v124, s[48:51], s72 offen offset:1024 sc1
  s_waitcnt vmcnt(11)
  v_mfma_f32_16x16x32_bf16 v[40:43], a[16:19], v[172:175], v[40:43]
  v_mfma_f32_16x16x32_bf16 v[44:47], a[20:23], v[172:175], v[44:47]
  v_mfma_f32_16x16x32_bf16 v[48:51], a[24:27], v[172:175], v[48:51]
  v_mfma_f32_16x16x32_bf16 v[52:55], a[28:31], v[172:175], v[52:55]
  buffer_load_dwordx4 v[172:175], v124, s[48:51], s72 offen offset:2048 sc1
  s_waitcnt vmcnt(11)
  v_mfma_f32_16x16x32_bf16 v[56:59], a[16:19], v[176:179], v[56:59]
  v_mfma_f32_16x16x32_bf16 v[60:63], a[20:23], v[176:179], v[60:63]
  v_mfma_f32_16x16x32_bf16 v[64:67], a[24:27], v[176:179], v[64:67]
  v_mfma_f32_16x16x32_bf16 v[68:71], a[28:31], v[176:179], v[68:71]
  buffer_load_dwordx4 v[176:179], v124, s[48:51], s72 offen offset:3072 sc1
  s_waitcnt vmcnt(11)
  v_mfma_f32_16x16x32_bf16 v[72:75], a[16:19], v[180:183], v[72:75]
  v_mfma_f32_16x16x32_bf16 v[76:79], a[20:23], v[180:183], v[76:79]
  v_mfma_f32_16x16x32_bf16 v[80:83], a[24:27], v[180:183], v[80:83]
  v_mfma_f32_16x16x32_bf16 v[84:87], a[28:31], v[180:183], v[84:87]
  buffer_load_dwordx4 v[180:183], v124, s[48:51], s73 offen offset:0 sc1
  s_waitcnt vmcnt(11)
  v_mfma_f32_16x16x32_bf16 v[88:91], a[16:19], v[184:187], v[88:91]
  v_mfma_f32_16x16x32_bf16 v[92:95], a[20:23], v[184:187], v[92:95]
  v_mfma_f32_16x16x32_bf16 v[96:99], a[24:27], v[184:187], v[96:99]
  v_mfma_f32_16x16x32_bf16 v[100:103], a[28:31], v[184:187], v[100:103]
  buffer_load_dwordx4 v[184:187], v124, s[48:51], s73 offen offset:1024 sc1
  s_waitcnt vmcnt(11)
  v_mfma_f32_16x16x32_bf16 v[8:11], a[32:35], v[140:143], v[8:11]
  s_add_u32 s70, s14, 6
  s_and_b32 s70, s70, 7
  v_mfma_f32_16x16x32_bf16 v[12:15], a[36:39], v[140:143], v[12:15]
  s_or_b32 s70, s70, 8
  s_mul_i32 s70, s70, 6144
  v_mfma_f32_16x16x32_bf16 v[16:19], a[40:43], v[140:143], v[16:19]
  s_add_u32 s70, s70, s8
  s_add_u32 s71, s70, 4096
  v_mfma_f32_16x16x32_bf16 v[20:23], a[44:47], v[140:143], v[20:23]
  buffer_load_dwordx4 v[140:143], v124, s[48:51], s70 offen offset:0 sc1
  s_waitcnt vmcnt(11)
  v_mfma_f32_16x16x32_bf16 v[24:27], a[32:35], v[144:147], v[24:27]
  v_mfma_f32_16x16x32_bf16 v[28:31], a[36:39], v[144:147], v[28:31]
  v_mfma_f32_16x16x32_bf16 v[32:35], a[40:43], v[144:147], v[32:35]
  v_mfma_f32_16x16x32_bf16 v[36:39], a[44:47], v[144:147], v[36:39]
  buffer_load_dwordx4 v[144:147], v124, s[48:51], s70 offen offset:1024 sc1
  s_waitcnt vmcnt(11)
  v_mfma_f32_16x16x32_bf16 v[40:43], a[32:35], v[148:151], v[40:43]
  v_mfma_f32_16x16x32_bf16 v[44:47], a[36:39], v[148:151], v[44:47]
  v_mfma_f32_16x16x32_bf16 v[48:51], a[40:43], v[148:151], v[48:51]
  v_mfma_f32_16x16x32_bf16 v[52:55], a[44:47], v[148:151], v[52:55]
  buffer_load_dwordx4 v[148:151], v124, s[48:51], s70 offen offset:2048 sc1
  s_waitcnt vmcnt(11)
  v_mfma_f32_16x16x32_bf16 v[56:59], a[32:35], v[152:155], v[56:59]
  v_mfma_f32_16x16x32_bf16 v[60:63], a[36:39], v[152:155], v[60:63]
  v_mfma_f32_16x16x32_bf16 v[64:67], a[40:43], v[152:155], v[64:67]
  v_mfma_f32_16x16x32_bf16 v[68:71], a[44:47], v[152:155], v[68:71]
  buffer_load_dwordx4 v[152:155], v124, s[48:51], s70 offen offset:3072 sc1
  s_waitcnt vmcnt(11)
  v_mfma_f32_16x16x32_bf16 v[72:75], a[32:35], v[156:159], v[72:75]
  v_mfma_f32_16x16x32_bf16 v[76:79], a[36:39], v[156:159], v[76:79]
  v_mfma_f32_16x16x32_bf16 v[80:83], a[40:43], v[156:159], v[80:83]
  v_mfma_f32_16x16x32_bf16 v[84:87], a[44:47], v[156:159], v[84:87]
  buffer_load_dwordx4 v[156:159], v124, s[48:51], s71 offen offset:0 sc1
  s_waitcnt vmcnt(11)
  v_mfma_f32_16x16x32_bf16 v[88:91], a[32:35], v[160:163], v[88:91]
  v_mfma_f32_16x16x32_bf16 v[92:95], a[36:39], v[160:163], v[92:95]
  v_mfma_f32_16x16x32_bf16 v[96:99], a[40:43], v[160:163], v[96:99]
  v_mfma_f32_16x16x32_bf16 v[100:103], a[44:47], v[160:163], v[100:103]
  buffer_load_dwordx4 v[160:163], v124, s[48:51], s71 offen offset:1024 sc1
  s_waitcnt vmcnt(11)
  v_mfma_f32_16x16x32_bf16 v[8:11], a[184:187], v[164:167], v[8:11]
  s_add_u32 s72, s14, 7
  s_and_b32 s72, s72, 7
  v_mfma_f32_16x16x32_bf16 v[12:15], a[188:191], v[164:167], v[12:15]
  s_or_b32 s72, s72, 8
  s_mul_i32 s72, s72, 6144
  v_mfma_f32_16x16x32_bf16 v[16:19], a[192:195], v[164:167], v[16:19]
  s_add_u32 s72, s72, s8
  s_add_u32 s73, s72, 4096
  v_mfma_f32_16x16x32_bf16 v[20:23], a[196:199], v[164:167], v[20:23]
  buffer_load_dwordx4 v[164:167], v124, s[48:51], s72 offen offset:0 sc1
  s_waitcnt vmcnt(11)
  v_mfma_f32_16x16x32_bf16 v[24:27], a[184:187], v[168:171], v[24:27]
  v_mfma_f32_16x16x32_bf16 v[28:31], a[188:191], v[168:171], v[28:31]
  v_mfma_f32_16x16x32_bf16 v[32:35], a[192:195], v[168:171], v[32:35]
  v_mfma_f32_16x16x32_bf16 v[36:39], a[196:199], v[168:171], v[36:39]
  buffer_load_dwordx4 v[168:171], v124, s[48:51], s72 offen offset:1024 sc1
  s_waitcnt vmcnt(11)
  v_mfma_f32_16x16x32_bf16 v[40:43], a[184:187], v[172:175], v[40:43]
  v_mfma_f32_16x16x32_bf16 v[44:47], a[188:191], v[172:175], v[44:47]
  v_mfma_f32_16x16x32_bf16 v[48:51], a[192:195], v[172:175], v[48:51]
  v_mfma_f32_16x16x32_bf16 v[52:55], a[196:199], v[172:175], v[52:55]
  buffer_load_dwordx4 v[172:175], v124, s[48:51], s72 offen offset:2048 sc1
  s_waitcnt vmcnt(11)
  v_mfma_f32_16x16x32_bf16 v[56:59], a[184:187], v[176:179], v[56:59]
  v_mfma_f32_16x16x32_bf16 v[60:63], a[188:191], v[176:179], v[60:63]
  v_mfma_f32_16x16x32_bf16 v[64:67], a[192:195], v[176:179], v[64:67]
  v_mfma_f32_16x16x32_bf16 v[68:71], a[196:199], v[176:179], v[68:71]
  buffer_load_dwordx4 v[176:179], v124, s[48:51], s72 offen offset:3072 sc1
  s_waitcnt vmcnt(11)
  v_mfma_f32_16x16x32_bf16 v[72:75], a[184:187], v[180:183], v[72:75]
  v_mfma_f32_16x16x32_bf16 v[76:79], a[188:191], v[180:183], v[76:79]
  v_mfma_f32_16x16x32_bf16 v[80:83], a[192:195], v[180:183], v[80:83]
  v_mfma_f32_16x16x32_bf16 v[84:87], a[196:199], v[180:183], v[84:87]
  buffer_load_dwordx4 v[180:183], v124, s[48:51], s73 offen offset:0 sc1
  s_waitcnt vmcnt(11)
  v_mfma_f32_16x16x32_bf16 v[88:91], a[184:187], v[184:187], v[88:91]
  v_mfma_f32_16x16x32_bf16 v[92:95], a[188:191], v[184:187], v[92:95]
  v_mfma_f32_16x16x32_bf16 v[96:99], a[192:195], v[184:187], v[96:99]
  v_mfma_f32_16x16x32_bf16 v[100:103], a[196:199], v[184:187], v[100:103]
  buffer_load_dwordx4 v[184:187], v124, s[48:51], s73 offen offset:1024 sc1
  s_waitcnt vmcnt(11)
  v_mfma_f32_16x16x32_bf16 v[8:11], a[200:203], v[140:143], v[8:11]
  s_add_u32 s70, s14, 0
  s_and_b32 s70, s70, 7
  v_mfma_f32_16x16x32_bf16 v[12:15], a[204:207], v[140:143], v[12:15]
  s_or_b32 s70, s70, 16
  s_mul_i32 s70, s70, 6144
  v_mfma_f32_16x16x32_bf16 v[16:19], a[208:211], v[140:143], v[16:19]
  s_add_u32 s70, s70, s8
  s_add_u32 s71, s70, 4096
  v_mfma_f32_16x16x32_bf16 v[20:23], a[212:215], v[140:143], v[20:23]
  buffer_load_dwordx4 v[140:143], v124, s[48:51], s70 offen offset:0 sc1
  s_waitcnt vmcnt(11)
  v_mfma_f32_16x16x32_bf16 v[24:27], a[200:203], v[144:147], v[24:27]
  v_mfma_f32_16x16x32_bf16 v[28:31], a[204:207], v[144:147], v[28:31]
  v_mfma_f32_16x16x32_bf16 v[32:35], a[208:211], v[144:147], v[32:35]
  v_mfma_f32_16x16x32_bf16 v[36:39], a[212:215], v[144:147], v[36:39]
  buffer_load_dwordx4 v[144:147], v124, s[48:51], s70 offen offset:1024 sc1
  s_waitcnt vmcnt(11)
  v_mfma_f32_16x16x32_bf16 v[40:43], a[200:203], v[148:151], v[40:43]
  v_mfma_f32_16x16x32_bf16 v[44:47], a[204:207], v[148:151], v[44:47]
  v_mfma_f32_16x16x32_bf16 v[48:51], a[208:211], v[148:151], v[48:51]
  v_mfma_f32_16x16x32_bf16 v[52:55], a[212:215], v[148:151], v[52:55]
  buffer_load_dwordx4 v[148:151], v124, s[48:51], s70 offen offset:2048 sc1
  s_waitcnt vmcnt(11)
  v_mfma_f32_16x16x32_bf16 v[56:59], a[200:203], v[152:155], v[56:59]
  v_mfma_f32_16x16x32_bf16 v[60:63], a[204:207], v[152:155], v[60:63]
  v_mfma_f32_16x16x32_bf16 v[64:67], a[208:211], v[152:155], v[64:67]
  v_mfma_f32_16x16x32_bf16 v[68:71], a[212:215], v[152:155], v[68:71]
  buffer_load_dwordx4 v[152:155], v124, s[48:51], s70 offen offset:3072 sc1
  s_waitcnt vmcnt(11)
  v_mfma_f32_16x16x32_bf16 v[72:75], a[200:203], v[156:159], v[72:75]
  v_mfma_f32_16x16x32_bf16 v[76:79], a[204:207], v[156:159], v[76:79]
  v_mfma_f32_16x16x32_bf16 v[80:83], a[208:211], v[156:159], v[80:83]
  v_mfma_f32_16x16x32_bf16 v[84:87], a[212:215], v[156:159], v[84:87]
  buffer_load_dwordx4 v[156:159], v124, s[48:51], s71 offen offset:0 sc1
  s_waitcnt vmcnt(11)
  v_mfma_f32_16x16x32_bf16 v[88:91], a[200:203], v[160:163], v[88:91]
  v_mfma_f32_16x16x32_bf16 v[92:95], a[204:207], v[160:163], v[92:95]
  v_mfma_f32_16x16x32_bf16 v[96:99], a[208:211], v[160:163], v[96:99]
  v_mfma_f32_16x16x32_bf16 v[100:103], a[212:215], v[160:163], v[100:103]
  buffer_load_dwordx4 v[160:163], v124, s[48:51], s71 offen offset:1024 sc1
  s_waitcnt vmcnt(11)
  v_mfma_f32_16x16x32_bf16 v[8:11], a[216:219], v[164:167], v[8:11]
  s_add_u32 s72, s14, 1
  s_and_b32 s72, s72, 7
  v_mfma_f32_16x16x32_bf16 v[12:15], a[220:223], v[164:167], v[12:15]
  s_or_b32 s72, s72, 16
  s_mul_i32 s72, s72, 6144
  v_mfma_f32_16x16x32_bf16 v[16:19], a[224:227], v[164:167], v[16:19]
  s_add_u32 s72, s72, s8
  s_add_u32 s73, s72, 4096
  v_mfma_f32_16x16x32_bf16 v[20:23], a[228:231], v[164:167], v[20:23]
  buffer_load_dwordx4 v[164:167], v124, s[48:51], s72 offen offset:0 sc1
  s_waitcnt vmcnt(11)
  v_mfma_f32_16x16x32_bf16 v[24:27], a[216:219], v[168:171], v[24:27]
  v_mfma_f32_16x16x32_bf16 v[28:31], a[220:223], v[168:171], v[28:31]
  v_mfma_f32_16x16x32_bf16 v[32:35], a[224:227], v[168:171], v[32:35]
  v_mfma_f32_16x16x32_bf16 v[36:39], a[228:231], v[168:171], v[36:39]
  buffer_load_dwordx4 v[168:171], v124, s[48:51], s72 offen offset:1024 sc1
  s_waitcnt vmcnt(11)
  v_mfma_f32_16x16x32_bf16 v[40:43], a[216:219], v[172:175], v[40:43]
  v_mfma_f32_16x16x32_bf16 v[44:47], a[220:223], v[172:175], v[44:47]
  v_mfma_f32_16x16x32_bf16 v[48:51], a[224:227], v[172:175], v[48:51]
  v_mfma_f32_16x16x32_bf16 v[52:55], a[228:231], v[172:175], v[52:55]
  buffer_load_dwordx4 v[172:175], v124, s[48:51], s72 offen offset:2048 sc1
  s_waitcnt vmcnt(11)
  v_mfma_f32_16x16x32_bf16 v[56:59], a[216:219], v[176:179], v[56:59]
  v_mfma_f32_16x16x32_bf16 v[60:63], a[220:223], v[176:179], v[60:63]
  v_mfma_f32_16x16x32_bf16 v[64:67], a[224:227], v[176:179], v[64:67]
  v_mfma_f32_16x16x32_bf16 v[68:71], a[228:231], v[176:179], v[68:71]
  buffer_load_dwordx4 v[176:179], v124, s[48:51], s72 offen offset:3072 sc1
  s_waitcnt vmcnt(11)
  v_mfma_f32_16x16x32_bf16 v[72:75], a[216:219], v[180:183], v[72:75]
  v_mfma_f32_16x16x32_bf16 v[76:79], a[220:223], v[180:183], v[76:79]
  v_mfma_f32_16x16x32_bf16 v[80:83], a[224:227], v[180:183], v[80:83]
  v_mfma_f32_16x16x32_bf16 v[84:87], a[228:231], v[180:183], v[84:87]
  buffer_load_dwordx4 v[180:183], v124, s[48:51], s73 offen offset:0 sc1
  s_waitcnt vmcnt(11)
  v_mfma_f32_16x16x32_bf16 v[88:91], a[216:219], v[184:187], v[88:91]
  v_mfma_f32_16x16x32_bf16 v[92:95], a[220:223], v[184:187], v[92:95]
  v_mfma_f32_16x16x32_bf16 v[96:99], a[224:227], v[184:187], v[96:99]
  v_mfma_f32_16x16x32_bf16 v[100:103], a[228:231], v[184:187], v[100:103]
  buffer_load_dwordx4 v[184:187], v124, s[48:51], s73 offen offset:1024 sc1
  s_waitcnt vmcnt(11)
  v_mfma_f32_16x16x32_bf16 v[8:11], v[188:191], v[140:143], v[8:11]
  s_add_u32 s70, s14, 2
  s_and_b32 s70, s70, 7
  v_mfma_f32_16x16x32_bf16 v[12:15], v[192:195], v[140:143], v[12:15]
  s_or_b32 s70, s70, 16
  s_mul_i32 s70, s70, 6144
  v_mfma_f32_16x16x32_bf16 v[16:19], v[196:199], v[140:143], v[16:19]
  s_add_u32 s70, s70, s8
  s_add_u32 s71, s70, 4096
  v_mfma_f32_16x16x32_bf16 v[20:23], v[200:203], v[140:143], v[20:23]
  buffer_load_dwordx4 v[140:143], v124, s[48:51], s70 offen offset:0 sc1
  s_waitcnt vmcnt(11)
  v_mfma_f32_16x16x32_bf16 v[24:27], v[188:191], v[144:147], v[24:27]
  v_mfma_f32_16x16x32_bf16 v[28:31], v[192:195], v[144:147], v[28:31]
  v_mfma_f32_16x16x32_bf16 v[32:35], v[196:199], v[144:147], v[32:35]
  v_mfma_f32_16x16x32_bf16 v[36:39], v[200:203], v[144:147], v[36:39]
  buffer_load_dwordx4 v[144:147], v124, s[48:51], s70 offen offset:1024 sc1
  s_waitcnt vmcnt(11)
  v_mfma_f32_16x16x32_bf16 v[40:43], v[188:191], v[148:151], v[40:43]
  v_mfma_f32_16x16x32_bf16 v[44:47], v[192:195], v[148:151], v[44:47]
  v_mfma_f32_16x16x32_bf16 v[48:51], v[196:199], v[148:151], v[48:51]
  v_mfma_f32_16x16x32_bf16 v[52:55], v[200:203], v[148:151], v[52:55]
  buffer_load_dwordx4 v[148:151], v124, s[48:51], s70 offen offset:2048 sc1
  s_waitcnt vmcnt(11)
  v_mfma_f32_16x16x32_bf16 v[56:59], v[188:191], v[152:155], v[56:59]
  v_mfma_f32_16x16x32_bf16 v[60:63], v[192:195], v[152:155], v[60:63]
  v_mfma_f32_16x16x32_bf16 v[64:67], v[196:199], v[152:155], v[64:67]
  v_mfma_f32_16x16x32_bf16 v[68:71], v[200:203], v[152:155], v[68:71]
  buffer_load_dwordx4 v[152:155], v124, s[48:51], s70 offen offset:3072 sc1
  s_waitcnt vmcnt(11)
  v_mfma_f32_16x16x32_bf16 v[72:75], v[188:191], v[156:159], v[72:75]
  v_mfma_f32_16x16x32_bf16 v[76:79], v[192:195], v[156:159], v[76:79]
  v_mfma_f32_16x16x32_bf16 v[80:83], v[196:199], v[156:159], v[80:83]
  v_mfma_f32_16x16x32_bf16 v[84:87], v[200:203], v[156:159], v[84:87]
  buffer_load_dwordx4 v[156:159], v124, s[48:51], s71 offen offset:0 sc1
  s_waitcnt vmcnt(11)
  v_mfma_f32_16x16x32_bf16 v[88:91], v[188:191], v[160:163], v[88:91]
  v_mfma_f32_16x16x32_bf16 v[92:95], v[192:195], v[160:163], v[92:95]
  v_mfma_f32_16x16x32_bf16 v[96:99], v[196:199], v[160:163], v[96:99]
  v_mfma_f32_16x16x32_bf16 v[100:103], v[200:203], v[160:163], v[100:103]
  buffer_load_dwordx4 v[160:163], v124, s[48:51], s71 offen offset:1024 sc1
  s_waitcnt vmcnt(11)
  v_mfma_f32_16x16x32_bf16 v[8:11], v[204:207], v[164:167], v[8:11]
  s_add_u32 s72, s14, 3
  s_and_b32 s72, s72, 7
  v_mfma_f32_16x16x32_bf16 v[12:15], v[208:211], v[164:167], v[12:15]
  s_or_b32 s72, s72, 16
  s_mul_i32 s72, s72, 6144
  v_mfma_f32_16x16x32_bf16 v[16:19], v[212:215], v[164:167], v[16:19]
  s_add_u32 s72, s72, s8
  s_add_u32 s73, s72, 4096
  v_mfma_f32_16x16x32_bf16 v[20:23], v[216:219], v[164:167], v[20:23]
  buffer_load_dwordx4 v[164:167], v124, s[48:51], s72 offen offset:0 sc1
  s_waitcnt vmcnt(11)
  v_mfma_f32_16x16x32_bf16 v[24:27], v[204:207], v[168:171], v[24:27]
  v_mfma_f32_16x16x32_bf16 v[28:31], v[208:211], v[168:171], v[28:31]
  v_mfma_f32_16x16x32_bf16 v[32:35], v[212:215], v[168:171], v[32:35]
  v_mfma_f32_16x16x32_bf16 v[36:39], v[216:219], v[168:171], v[36:39]
  buffer_load_dwordx4 v[168:171], v124, s[48:51], s72 offen offset:1024 sc1
  s_waitcnt vmcnt(11)
  v_mfma_f32_16x16x32_bf16 v[40:43], v[204:207], v[172:175], v[40:43]
  v_mfma_f32_16x16x32_bf16 v[44:47], v[208:211], v[172:175], v[44:47]
  v_mfma_f32_16x16x32_bf16 v[48:51], v[212:215], v[172:175], v[48:51]
  v_mfma_f32_16x16x32_bf16 v[52:55], v[216:219], v[172:175], v[52:55]
  buffer_load_dwordx4 v[172:175], v124, s[48:51], s72 offen offset:2048 sc1
  s_waitcnt vmcnt(11)
  v_mfma_f32_16x16x32_bf16 v[56:59], v[204:207], v[176:179], v[56:59]
  v_mfma_f32_16x16x32_bf16 v[60:63], v[208:211], v[176:179], v[60:63]
  v_mfma_f32_16x16x32_bf16 v[64:67], v[212:215], v[176:179], v[64:67]
  v_mfma_f32_16x16x32_bf16 v[68:71], v[216:219], v[176:179], v[68:71]
  buffer_load_dwordx4 v[176:179], v124, s[48:51], s72 offen offset:3072 sc1
  s_waitcnt vmcnt(11)
  v_mfma_f32_16x16x32_bf16 v[72:75], v[204:207], v[180:183], v[72:75]
  v_mfma_f32_16x16x32_bf16 v[76:79], v[208:211], v[180:183], v[76:79]
  v_mfma_f32_16x16x32_bf16 v[80:83], v[212:215], v[180:183], v[80:83]
  v_mfma_f32_16x16x32_bf16 v[84:87], v[216:219], v[180:183], v[84:87]
  buffer_load_dwordx4 v[180:183], v124, s[48:51], s73 offen offset:0 sc1
  s_waitcnt vmcnt(11)
  v_mfma_f32_16x16x32_bf16 v[88:91], v[204:207], v[184:187], v[88:91]
  v_mfma_f32_16x16x32_bf16 v[92:95], v[208:211], v[184:187], v[92:95]
  v_mfma_f32_16x16x32_bf16 v[96:99], v[212:215], v[184:187], v[96:99]
  v_mfma_f32_16x16x32_bf16 v[100:103], v[216:219], v[184:187], v[100:103]
  buffer_load_dwordx4 v[184:187], v124, s[48:51], s73 offen offset:1024 sc1
  s_waitcnt vmcnt(11)
  v_mfma_f32_16x16x32_bf16 v[8:11], v[220:223], v[140:143], v[8:11]
  s_add_u32 s70, s14, 4
  s_and_b32 s70, s70, 7
  v_mfma_f32_16x16x32_bf16 v[12:15], v[224:227], v[140:143], v[12:15]
  s_or_b32 s70, s70, 16
  s_mul_i32 s70, s70, 6144
  v_mfma_f32_16x16x32_bf16 v[16:19], v[228:231], v[140:143], v[16:19]
  s_add_u32 s70, s70, s8
  s_add_u32 s71, s70, 4096
  v_mfma_f32_16x16x32_bf16 v[20:23], v[232:235], v[140:143], v[20:23]
  buffer_load_dwordx4 v[140:143], v124, s[48:51], s70 offen offset:0 sc1
  s_waitcnt vmcnt(11)
  v_mfma_f32_16x16x32_bf16 v[24:27], v[220:223], v[144:147], v[24:27]
  v_mfma_f32_16x16x32_bf16 v[28:31], v[224:227], v[144:147], v[28:31]
  v_mfma_f32_16x16x32_bf16 v[32:35], v[228:231], v[144:147], v[32:35]
  v_mfma_f32_16x16x32_bf16 v[36:39], v[232:235], v[144:147], v[36:39]
  buffer_load_dwordx4 v[144:147], v124, s[48:51], s70 offen offset:1024 sc1
  s_waitcnt vmcnt(11)
  v_mfma_f32_16x16x32_bf16 v[40:43], v[220:223], v[148:151], v[40:43]
  v_mfma_f32_16x16x32_bf16 v[44:47], v[224:227], v[148:151], v[44:47]
  v_mfma_f32_16x16x32_bf16 v[48:51], v[228:231], v[148:151], v[48:51]
  v_mfma_f32_16x16x32_bf16 v[52:55], v[232:235], v[148:151], v[52:55]
  buffer_load_dwordx4 v[148:151], v124, s[48:51], s70 offen offset:2048 sc1
  s_waitcnt vmcnt(11)
  v_mfma_f32_16x16x32_bf16 v[56:59], v[220:223], v[152:155], v[56:59]
  v_mfma_f32_16x16x32_bf16 v[60:63], v[224:227], v[152:155], v[60:63]
  v_mfma_f32_16x16x32_bf16 v[64:67], v[228:231], v[152:155], v[64:67]
  v_mfma_f32_16x16x32_bf16 v[68:71], v[232:235], v[152:155], v[68:71]
  buffer_load_dwordx4 v[152:155], v124, s[48:51], s70 offen offset:3072 sc1
  s_waitcnt vmcnt(11)
  v_mfma_f32_16x16x32_bf16 v[72:75], v[220:223], v[156:159], v[72:75]
  v_mfma_f32_16x16x32_bf16 v[76:79], v[224:227], v[156:159], v[76:79]
  v_mfma_f32_16x16x32_bf16 v[80:83], v[228:231], v[156:159], v[80:83]
  v_mfma_f32_16x16x32_bf16 v[84:87], v[232:235], v[156:159], v[84:87]
  buffer_load_dwordx4 v[156:159], v124, s[48:51], s71 offen offset:0 sc1
  s_waitcnt vmcnt(11)
  v_mfma_f32_16x16x32_bf16 v[88:91], v[220:223], v[160:163], v[88:91]
  v_mfma_f32_16x16x32_bf16 v[92:95], v[224:227], v[160:163], v[92:95]
  v_mfma_f32_16x16x32_bf16 v[96:99], v[228:231], v[160:163], v[96:99]
  v_mfma_f32_16x16x32_bf16 v[100:103], v[232:235], v[160:163], v[100:103]
  buffer_load_dwordx4 v[160:163], v124, s[48:51], s71 offen offset:1024 sc1
  s_waitcnt vmcnt(11)
  v_mfma_f32_16x16x32_bf16 v[8:11], v[236:239], v[164:167], v[8:11]
  s_add_u32 s72, s14, 5
  s_and_b32 s72, s72, 7
  v_mfma_f32_16x16x32_bf16 v[12:15], v[240:243], v[164:167], v[12:15]
  s_or_b32 s72, s72, 16
  s_mul_i32 s72, s72, 6144
  v_mfma_f32_16x16x32_bf16 v[16:19], v[244:247], v[164:167], v[16:19]
  s_add_u32 s72, s72, s8
  s_add_u32 s73, s72, 4096
  v_mfma_f32_16x16x32_bf16 v[20:23], v[248:251], v[164:167], v[20:23]
  v_add_u32 v4, s40, v134
  s_waitcnt vmcnt(10)
  v_mfma_f32_16x16x32_bf16 v[24:27], v[236:239], v[168:171], v[24:27]
  v_add_u32 v5, s40, v135
  v_add_u32 v6, s40, v136
  v_mfma_f32_16x16x32_bf16 v[28:31], v[240:243], v[168:171], v[28:31]
  v_add_u32 v7, s40, v137
  ds_read_b64_tr_b16 a[48:49], v4 offset:0
  v_mfma_f32_16x16x32_bf16 v[32:35], v[244:247], v[168:171], v[32:35]
  ds_read_b64_tr_b16 a[50:51], v4 offset:2048
  ds_read_b64_tr_b16 a[52:53], v5 offset:0
  v_mfma_f32_16x16x32_bf16 v[36:39], v[248:251], v[168:171], v[36:39]
  ds_read_b64_tr_b16 a[54:55], v5 offset:2048
  ds_read_b64_tr_b16 a[56:57], v6 offset:0
  s_waitcnt vmcnt(9)
  v_mfma_f32_16x16x32_bf16 v[40:43], v[236:239], v[172:175], v[40:43]
  ds_read_b64_tr_b16 a[58:59], v6 offset:2048
  ds_read_b64_tr_b16 a[60:61], v7 offset:0
  v_mfma_f32_16x16x32_bf16 v[44:47], v[240:243], v[172:175], v[44:47]
  ds_read_b64_tr_b16 a[62:63], v7 offset:2048
  buffer_load_dwordx4 v[164:167], v124, s[48:51], s72 offen offset:0 sc1
  v_mfma_f32_16x16x32_bf16 v[48:51], v[244:247], v[172:175], v[48:51]
  buffer_load_dwordx4 v[168:171], v124, s[48:51], s72 offen offset:1024 sc1
  v_mfma_f32_16x16x32_bf16 v[52:55], v[248:251], v[172:175], v[52:55]
  buffer_load_dwordx4 v[172:175], v124, s[48:51], s72 offen offset:2048 sc1
  s_waitcnt vmcnt(11)
  v_mfma_f32_16x16x32_bf16 v[56:59], v[236:239], v[176:179], v[56:59]
  v_mfma_f32_16x16x32_bf16 v[60:63], v[240:243], v[176:179], v[60:63]
  v_mfma_f32_16x16x32_bf16 v[64:67], v[244:247], v[176:179], v[64:67]
  v_mfma_f32_16x16x32_bf16 v[68:71], v[248:251], v[176:179], v[68:71]
  buffer_load_dwordx4 v[176:179], v124, s[48:51], s72 offen offset:3072 sc1
  s_waitcnt vmcnt(11)
  v_mfma_f32_16x16x32_bf16 v[72:75], v[236:239], v[180:183], v[72:75]
  v_mfma_f32_16x16x32_bf16 v[76:79], v[240:243], v[180:183], v[76:79]
  v_mfma_f32_16x16x32_bf16 v[80:83], v[244:247], v[180:183], v[80:83]
  v_mfma_f32_16x16x32_bf16 v[84:87], v[248:251], v[180:183], v[84:87]
  buffer_load_dwordx4 v[180:183], v124, s[48:51], s73 offen offset:0 sc1
  s_waitcnt vmcnt(11)
  v_mfma_f32_16x16x32_bf16 v[88:91], v[236:239], v[184:187], v[88:91]
  v_mfma_f32_16x16x32_bf16 v[92:95], v[240:243], v[184:187], v[92:95]
  v_mfma_f32_16x16x32_bf16 v[96:99], v[244:247], v[184:187], v[96:99]
  v_mfma_f32_16x16x32_bf16 v[100:103], v[248:251], v[184:187], v[100:103]
  buffer_load_dwordx4 v[184:187], v124, s[48:51], s73 offen offset:1024 sc1
  s_waitcnt lgkmcnt(0)
  s_waitcnt vmcnt(11)
  v_mfma_f32_16x16x32_bf16 v[8:11], a[48:51], v[140:143], v[8:11]
  s_add_u32 s70, s14, 6
  s_and_b32 s70, s70, 7
  v_mfma_f32_16x16x32_bf16 v[12:15], a[52:55], v[140:143], v[12:15]
  s_or_b32 s70, s70, 16
  s_mul_i32 s70, s70, 6144
  v_mfma_f32_16x16x32_bf16 v[16:19], a[56:59], v[140:143], v[16:19]
  s_add_u32 s70, s70, s8
  s_add_u32 s71, s70, 4096
  v_mfma_f32_16x16x32_bf16 v[20:23], a[60:63], v[140:143], v[20:23]
  v_add_u32 v4, s41, v134
  s_waitcnt vmcnt(10)
  v_mfma_f32_16x16x32_bf16 v[24:27], a[48:51], v[144:147], v[24:27]
  v_add_u32 v5, s41, v135
  v_add_u32 v6, s41, v136
  v_mfma_f32_16x16x32_bf16 v[28:31], a[52:55], v[144:147], v[28:31]
  v_add_u32 v7, s41, v137
  ds_read_b64_tr_b16 a[64:65], v4 offset:0
  v_mfma_f32_16x16x32_bf16 v[32:35], a[56:59], v[144:147], v[32:35]
  ds_read_b64_tr_b16 a[66:67], v4 offset:2048
  ds_read_b64_tr_b16 a[68:69], v5 offset:0
  v_mfma_f32_16x16x32_bf16 v[36:39], a[60:63], v[144:147], v[36:39]
  ds_read_b64_tr_b16 a[70:71], v5 offset:2048
  ds_read_b64_tr_b16 a[72:73], v6 offset:0
  s_waitcnt vmcnt(9)
  v_mfma_f32_16x16x32_bf16 v[40:43], a[48:51], v[148:151], v[40:43]
  ds_read_b64_tr_b16 a[74:75], v6 offset:2048
  ds_read_b64_tr_b16 a[76:77], v7 offset:0
  v_mfma_f32_16x16x32_bf16 v[44:47], a[52:55], v[148:151], v[44:47]
  ds_read_b64_tr_b16 a[78:79], v7 offset:2048
  buffer_load_dwordx4 v[140:143], v124, s[48:51], s70 offen offset:0 sc1
  v_mfma_f32_16x16x32_bf16 v[48:51], a[56:59], v[148:151], v[48:51]
  buffer_load_dwordx4 v[144:147], v124, s[48:51], s70 offen offset:1024 sc1
  s_mov_b32 m0, s40
  v_mfma_f32_16x16x32_bf16 v[52:55], a[60:63], v[148:151], v[52:55]
  buffer_load_dwordx4 v[148:151], v124, s[48:51], s70 offen offset:2048 sc1
  s_add_u32 s15, s14, 6
  s_waitcnt vmcnt(11)
  v_mfma_f32_16x16x32_bf16 v[56:59], a[48:51], v[152:155], v[56:59]
  s_and_b32 s15, s15, 7
  s_or_b32 s15, s15, 24
  v_mfma_f32_16x16x32_bf16 v[60:63], a[52:55], v[152:155], v[60:63]
  s_lshl_b32 s15, s15, 16
  v_mfma_f32_16x16x32_bf16 v[64:67], a[56:59], v[152:155], v[64:67]
  v_mfma_f32_16x16x32_bf16 v[68:71], a[60:63], v[152:155], v[68:71]
  buffer_load_dwordx4 v[152:155], v124, s[48:51], s70 offen offset:3072 sc1
  s_add_u32 s15, s15, s9
  s_waitcnt vmcnt(11)
  v_mfma_f32_16x16x32_bf16 v[72:75], a[48:51], v[156:159], v[72:75]
  v_mfma_f32_16x16x32_bf16 v[76:79], a[52:55], v[156:159], v[76:79]
  buffer_load_dwordx4 v130, s[52:55], s15 offen offset:0  lds
  v_mfma_f32_16x16x32_bf16 v[80:83], a[56:59], v[156:159], v[80:83]
  v_mfma_f32_16x16x32_bf16 v[84:87], a[60:63], v[156:159], v[84:87]
  buffer_load_dwordx4 v[156:159], v124, s[48:51], s71 offen offset:0 sc1
  buffer_load_dwordx4 v131, s[52:55], s15 offen offset:1024  lds
  s_waitcnt vmcnt(13)
  v_mfma_f32_16x16x32_bf16 v[88:91], a[48:51], v[160:163], v[88:91]
  v_mfma_f32_16x16x32_bf16 v[92:95], a[52:55], v[160:163], v[92:95]
  buffer_load_dwordx4 v132, s[52:55], s15 offen offset:2048  lds
  v_mfma_f32_16x16x32_bf16 v[96:99], a[56:59], v[160:163], v[96:99]
  v_mfma_f32_16x16x32_bf16 v[100:103], a[60:63], v[160:163], v[100:103]
  buffer_load_dwordx4 v[160:163], v124, s[48:51], s71 offen offset:1024 sc1
  buffer_load_dwordx4 v133, s[52:55], s15 offen offset:3072  lds
  s_waitcnt lgkmcnt(0)
  s_waitcnt vmcnt(15)
  v_mfma_f32_16x16x32_bf16 v[8:11], a[64:67], v[164:167], v[8:11]
  s_add_u32 s72, s14, 7
  s_and_b32 s72, s72, 7
  v_mfma_f32_16x16x32_bf16 v[12:15], a[68:71], v[164:167], v[12:15]
  s_or_b32 s72, s72, 16
  s_mul_i32 s72, s72, 6144
  v_mfma_f32_16x16x32_bf16 v[16:19], a[72:75], v[164:167], v[16:19]
  s_add_u32 s72, s72, s8
  s_add_u32 s73, s72, 4096
  v_mfma_f32_16x16x32_bf16 v[20:23], a[76:79], v[164:167], v[20:23]
  v_add_u32 v4, s42, v134
  s_waitcnt vmcnt(14)
  v_mfma_f32_16x16x32_bf16 v[24:27], a[64:67], v[168:171], v[24:27]
  v_add_u32 v5, s42, v135
  v_add_u32 v6, s42, v136
  v_mfma_f32_16x16x32_bf16 v[28:31], a[68:71], v[168:171], v[28:31]
  v_add_u32 v7, s42, v137
  ds_read_b64_tr_b16 a[48:49], v4 offset:0
  v_mfma_f32_16x16x32_bf16 v[32:35], a[72:75], v[168:171], v[32:35]
  ds_read_b64_tr_b16 a[50:51], v4 offset:2048
  ds_read_b64_tr_b16 a[52:53], v5 offset:0
  v_mfma_f32_16x16x32_bf16 v[36:39], a[76:79], v[168:171], v[36:39]
  ds_read_b64_tr_b16 a[54:55], v5 offset:2048
  ds_read_b64_tr_b16 a[56:57], v6 offset:0
  s_waitcnt vmcnt(13)
  v_mfma_f32_16x16x32_bf16 v[40:43], a[64:67], v[172:175], v[40:43]
  ds_read_b64_tr_b16 a[58:59], v6 offset:2048
  ds_read_b64_tr_b16 a[60:61], v7 offset:0
  v_mfma_f32_16x16x32_bf16 v[44:47], a[68:71], v[172:175], v[44:47]
  ds_read_b64_tr_b16 a[62:63], v7 offset:2048
  buffer_load_dwordx4 v[164:167], v124, s[48:51], s72 offen offset:0 sc1
  v_mfma_f32_16x16x32_bf16 v[48:51], a[72:75], v[172:175], v[48:51]
  buffer_load_dwordx4 v[168:171], v124, s[48:51], s72 offen offset:1024 sc1
  s_mov_b32 m0, s41
  v_mfma_f32_16x16x32_bf16 v[52:55], a[76:79], v[172:175], v[52:55]
  buffer_load_dwordx4 v[172:175], v124, s[48:51], s72 offen offset:2048 sc1
  s_add_u32 s15, s14, 7
  s_waitcnt vmcnt(15)
  v_mfma_f32_16x16x32_bf16 v[56:59], a[64:67], v[176:179], v[56:59]
  s_and_b32 s15, s15, 7
  s_or_b32 s15, s15, 24
  v_mfma_f32_16x16x32_bf16 v[60:63], a[68:71], v[176:179], v[60:63]
  s_lshl_b32 s15, s15, 16
  v_mfma_f32_16x16x32_bf16 v[64:67], a[72:75], v[176:179], v[64:67]
  v_mfma_f32_16x16x32_bf16 v[68:71], a[76:79], v[176:179], v[68:71]
  buffer_load_dwordx4 v[176:179], v124, s[48:51], s72 offen offset:3072 sc1
  s_add_u32 s15, s15, s9
  s_waitcnt vmcnt(15)
  v_mfma_f32_16x16x32_bf16 v[72:75], a[64:67], v[180:183], v[72:75]
  v_mfma_f32_16x16x32_bf16 v[76:79], a[68:71], v[180:183], v[76:79]
  buffer_load_dwordx4 v130, s[52:55], s15 offen offset:0  lds
  v_mfma_f32_16x16x32_bf16 v[80:83], a[72:75], v[180:183], v[80:83]
  v_mfma_f32_16x16x32_bf16 v[84:87], a[76:79], v[180:183], v[84:87]
  buffer_load_dwordx4 v[180:183], v124, s[48:51], s73 offen offset:0 sc1
  buffer_load_dwordx4 v131, s[52:55], s15 offen offset:1024  lds
  s_waitcnt vmcnt(17)
  v_mfma_f32_16x16x32_bf16 v[88:91], a[64:67], v[184:187], v[88:91]
  v_mfma_f32_16x16x32_bf16 v[92:95], a[68:71], v[184:187], v[92:95]
  buffer_load_dwordx4 v132, s[52:55], s15 offen offset:2048  lds
  v_mfma_f32_16x16x32_bf16 v[96:99], a[72:75], v[184:187], v[96:99]
  v_mfma_f32_16x16x32_bf16 v[100:103], a[76:79], v[184:187], v[100:103]
  buffer_load_dwordx4 v[184:187], v124, s[48:51], s73 offen offset:1024 sc1
  buffer_load_dwordx4 v133, s[52:55], s15 offen offset:3072  lds
  s_waitcnt lgkmcnt(0)
  s_waitcnt vmcnt(19)
  v_mfma_f32_16x16x32_bf16 v[8:11], a[48:51], v[140:143], v[8:11]
  s_add_u32 s70, s14, 0
  s_and_b32 s70, s70, 7
  v_mfma_f32_16x16x32_bf16 v[12:15], a[52:55], v[140:143], v[12:15]
  s_or_b32 s70, s70, 24
  s_mul_i32 s70, s70, 6144
  v_mfma_f32_16x16x32_bf16 v[16:19], a[56:59], v[140:143], v[16:19]
  s_add_u32 s70, s70, s8
  s_add_u32 s71, s70, 4096
  v_mfma_f32_16x16x32_bf16 v[20:23], a[60:63], v[140:143], v[20:23]
  v_add_u32 v4, s43, v134
  s_waitcnt vmcnt(18)
  v_mfma_f32_16x16x32_bf16 v[24:27], a[48:51], v[144:147], v[24:27]
  v_add_u32 v5, s43, v135
  v_add_u32 v6, s43, v136
  v_mfma_f32_16x16x32_bf16 v[28:31], a[52:55], v[144:147], v[28:31]
  v_add_u32 v7, s43, v137
  ds_read_b64_tr_b16 a[64:65], v4 offset:0
  v_mfma_f32_16x16x32_bf16 v[32:35], a[56:59], v[144:147], v[32:35]
  ds_read_b64_tr_b16 a[66:67], v4 offset:2048
  ds_read_b64_tr_b16 a[68:69], v5 offset:0
  v_mfma_f32_16x16x32_bf16 v[36:39], a[60:63], v[144:147], v[36:39]
  ds_read_b64_tr_b16 a[70:71], v5 offset:2048
  ds_read_b64_tr_b16 a[72:73], v6 offset:0
  s_waitcnt vmcnt(17)
  v_mfma_f32_16x16x32_bf16 v[40:43], a[48:51], v[148:151], v[40:43]
  ds_read_b64_tr_b16 a[74:75], v6 offset:2048
  ds_read_b64_tr_b16 a[76:77], v7 offset:0
  v_mfma_f32_16x16x32_bf16 v[44:47], a[52:55], v[148:151], v[44:47]
  ds_read_b64_tr_b16 a[78:79], v7 offset:2048
  buffer_load_dwordx4 v[140:143], v124, s[48:51], s70 offen offset:0 sc1
  v_mfma_f32_16x16x32_bf16 v[48:51], a[56:59], v[148:151], v[48:51]
  buffer_load_dwordx4 v[144:147], v124, s[48:51], s70 offen offset:1024 sc1
  v_mfma_f32_16x16x32_bf16 v[52:55], a[60:63], v[148:151], v[52:55]
  buffer_load_dwordx4 v[148:151], v124, s[48:51], s70 offen offset:2048 sc1
  s_waitcnt vmcnt(19)
  v_mfma_f32_16x16x32_bf16 v[56:59], a[48:51], v[152:155], v[56:59]
  v_mfma_f32_16x16x32_bf16 v[60:63], a[52:55], v[152:155], v[60:63]
  v_mfma_f32_16x16x32_bf16 v[64:67], a[56:59], v[152:155], v[64:67]
  v_mfma_f32_16x16x32_bf16 v[68:71], a[60:63], v[152:155], v[68:71]
  buffer_load_dwordx4 v[152:155], v124, s[48:51], s70 offen offset:3072 sc1
  s_waitcnt vmcnt(18)
  v_mfma_f32_16x16x32_bf16 v[72:75], a[48:51], v[156:159], v[72:75]
  v_mfma_f32_16x16x32_bf16 v[76:79], a[52:55], v[156:159], v[76:79]
  v_mfma_f32_16x16x32_bf16 v[80:83], a[56:59], v[156:159], v[80:83]
  v_mfma_f32_16x16x32_bf16 v[84:87], a[60:63], v[156:159], v[84:87]
  buffer_load_dwordx4 v[156:159], v124, s[48:51], s71 offen offset:0 sc1
  s_waitcnt vmcnt(16)
  v_mfma_f32_16x16x32_bf16 v[88:91], a[48:51], v[160:163], v[88:91]
  v_mfma_f32_16x16x32_bf16 v[92:95], a[52:55], v[160:163], v[92:95]
  v_mfma_f32_16x16x32_bf16 v[96:99], a[56:59], v[160:163], v[96:99]
  v_mfma_f32_16x16x32_bf16 v[100:103], a[60:63], v[160:163], v[100:103]
  buffer_load_dwordx4 v[160:163], v124, s[48:51], s71 offen offset:1024 sc1
  s_waitcnt lgkmcnt(0)
  s_waitcnt vmcnt(15)
  v_mfma_f32_16x16x32_bf16 v[8:11], a[64:67], v[164:167], v[8:11]
  s_add_u32 s72, s14, 1
  s_and_b32 s72, s72, 7
  v_mfma_f32_16x16x32_bf16 v[12:15], a[68:71], v[164:167], v[12:15]
  s_or_b32 s72, s72, 24
  s_mul_i32 s72, s72, 6144
  v_mfma_f32_16x16x32_bf16 v[16:19], a[72:75], v[164:167], v[16:19]
  s_add_u32 s72, s72, s8
  s_add_u32 s73, s72, 4096
  v_mfma_f32_16x16x32_bf16 v[20:23], a[76:79], v[164:167], v[20:23]
  v_add_u32 v4, s66, v134
  s_waitcnt vmcnt(14)
  v_mfma_f32_16x16x32_bf16 v[24:27], a[64:67], v[168:171], v[24:27]
  v_add_u32 v5, s66, v135
  v_add_u32 v6, s66, v136
  v_mfma_f32_16x16x32_bf16 v[28:31], a[68:71], v[168:171], v[28:31]
  v_add_u32 v7, s66, v137
  ds_read_b64_tr_b16 a[48:49], v4 offset:0
  v_mfma_f32_16x16x32_bf16 v[32:35], a[72:75], v[168:171], v[32:35]
  ds_read_b64_tr_b16 a[50:51], v4 offset:2048
  ds_read_b64_tr_b16 a[52:53], v5 offset:0
  v_mfma_f32_16x16x32_bf16 v[36:39], a[76:79], v[168:171], v[36:39]
  ds_read_b64_tr_b16 a[54:55], v5 offset:2048
  ds_read_b64_tr_b16 a[56:57], v6 offset:0
  s_waitcnt vmcnt(13)
  v_mfma_f32_16x16x32_bf16 v[40:43], a[64:67], v[172:175], v[40:43]
  ds_read_b64_tr_b16 a[58:59], v6 offset:2048
  ds_read_b64_tr_b16 a[60:61], v7 offset:0
  v_mfma_f32_16x16x32_bf16 v[44:47], a[68:71], v[172:175], v[44:47]
  ds_read_b64_tr_b16 a[62:63], v7 offset:2048
  buffer_load_dwordx4 v[164:167], v124, s[48:51], s72 offen offset:0 sc1
  v_mfma_f32_16x16x32_bf16 v[48:51], a[72:75], v[172:175], v[48:51]
  buffer_load_dwordx4 v[168:171], v124, s[48:51], s72 offen offset:1024 sc1
  v_mfma_f32_16x16x32_bf16 v[52:55], a[76:79], v[172:175], v[52:55]
  buffer_load_dwordx4 v[172:175], v124, s[48:51], s72 offen offset:2048 sc1
  s_waitcnt vmcnt(15)
  v_mfma_f32_16x16x32_bf16 v[56:59], a[64:67], v[176:179], v[56:59]
  v_mfma_f32_16x16x32_bf16 v[60:63], a[68:71], v[176:179], v[60:63]
  v_mfma_f32_16x16x32_bf16 v[64:67], a[72:75], v[176:179], v[64:67]
  v_mfma_f32_16x16x32_bf16 v[68:71], a[76:79], v[176:179], v[68:71]
  buffer_load_dwordx4 v[176:179], v124, s[48:51], s72 offen offset:3072 sc1
  s_waitcnt vmcnt(14)
  v_mfma_f32_16x16x32_bf16 v[72:75], a[64:67], v[180:183], v[72:75]
  v_mfma_f32_16x16x32_bf16 v[76:79], a[68:71], v[180:183], v[76:79]
  v_mfma_f32_16x16x32_bf16 v[80:83], a[72:75], v[180:183], v[80:83]
  v_mfma_f32_16x16x32_bf16 v[84:87], a[76:79], v[180:183], v[84:87]
  buffer_load_dwordx4 v[180:183], v124, s[48:51], s73 offen offset:0 sc1
  s_waitcnt vmcnt(12)
  v_mfma_f32_16x16x32_bf16 v[88:91], a[64:67], v[184:187], v[88:91]
  v_mfma_f32_16x16x32_bf16 v[92:95], a[68:71], v[184:187], v[92:95]
  v_mfma_f32_16x16x32_bf16 v[96:99], a[72:75], v[184:187], v[96:99]
  v_mfma_f32_16x16x32_bf16 v[100:103], a[76:79], v[184:187], v[100:103]
  buffer_load_dwordx4 v[184:187], v124, s[48:51], s73 offen offset:1024 sc1
  s_waitcnt lgkmcnt(0)
  s_waitcnt vmcnt(11)
  v_mfma_f32_16x16x32_bf16 v[8:11], a[48:51], v[140:143], v[8:11]
  s_add_u32 s70, s14, 2
  s_and_b32 s70, s70, 7
  v_mfma_f32_16x16x32_bf16 v[12:15], a[52:55], v[140:143], v[12:15]
  s_or_b32 s70, s70, 24
  s_mul_i32 s70, s70, 6144
  v_mfma_f32_16x16x32_bf16 v[16:19], a[56:59], v[140:143], v[16:19]
  s_add_u32 s70, s70, s8
  s_add_u32 s71, s70, 4096
  v_mfma_f32_16x16x32_bf16 v[20:23], a[60:63], v[140:143], v[20:23]
  v_add_u32 v4, s74, v134
  s_waitcnt vmcnt(10)
  v_mfma_f32_16x16x32_bf16 v[24:27], a[48:51], v[144:147], v[24:27]
  v_add_u32 v5, s74, v135
  v_add_u32 v6, s74, v136
  v_mfma_f32_16x16x32_bf16 v[28:31], a[52:55], v[144:147], v[28:31]
  v_add_u32 v7, s74, v137
  ds_read_b64_tr_b16 a[64:65], v4 offset:0
  v_mfma_f32_16x16x32_bf16 v[32:35], a[56:59], v[144:147], v[32:35]
  ds_read_b64_tr_b16 a[66:67], v4 offset:2048
  ds_read_b64_tr_b16 a[68:69], v5 offset:0
  v_mfma_f32_16x16x32_bf16 v[36:39], a[60:63], v[144:147], v[36:39]
  ds_read_b64_tr_b16 a[70:71], v5 offset:2048
  ds_read_b64_tr_b16 a[72:73], v6 offset:0
  s_waitcnt vmcnt(9)
  v_mfma_f32_16x16x32_bf16 v[40:43], a[48:51], v[148:151], v[40:43]
  ds_read_b64_tr_b16 a[74:75], v6 offset:2048
  ds_read_b64_tr_b16 a[76:77], v7 offset:0
  v_mfma_f32_16x16x32_bf16 v[44:47], a[52:55], v[148:151], v[44:47]
  ds_read_b64_tr_b16 a[78:79], v7 offset:2048
  buffer_load_dwordx4 v[140:143], v124, s[48:51], s70 offen offset:0 sc1
  v_mfma_f32_16x16x32_bf16 v[48:51], a[56:59], v[148:151], v[48:51]
  buffer_load_dwordx4 v[144:147], v124, s[48:51], s70 offen offset:1024 sc1
  v_mfma_f32_16x16x32_bf16 v[52:55], a[60:63], v[148:151], v[52:55]
  buffer_load_dwordx4 v[148:151], v124, s[48:51], s70 offen offset:2048 sc1
  s_waitcnt vmcnt(11)
  v_mfma_f32_16x16x32_bf16 v[56:59], a[48:51], v[152:155], v[56:59]
  v_mfma_f32_16x16x32_bf16 v[60:63], a[52:55], v[152:155], v[60:63]
  v_mfma_f32_16x16x32_bf16 v[64:67], a[56:59], v[152:155], v[64:67]
  v_mfma_f32_16x16x32_bf16 v[68:71], a[60:63], v[152:155], v[68:71]
  buffer_load_dwordx4 v[152:155], v124, s[48:51], s70 offen offset:3072 sc1
  s_waitcnt vmcnt(11)
  v_mfma_f32_16x16x32_bf16 v[72:75], a[48:51], v[156:159], v[72:75]
  v_mfma_f32_16x16x32_bf16 v[76:79], a[52:55], v[156:159], v[76:79]
  v_mfma_f32_16x16x32_bf16 v[80:83], a[56:59], v[156:159], v[80:83]
  v_mfma_f32_16x16x32_bf16 v[84:87], a[60:63], v[156:159], v[84:87]
  buffer_load_dwordx4 v[156:159], v124, s[48:51], s71 offen offset:0 sc1
  s_waitcnt vmcnt(11)
  v_mfma_f32_16x16x32_bf16 v[88:91], a[48:51], v[160:163], v[88:91]
  v_mfma_f32_16x16x32_bf16 v[92:95], a[52:55], v[160:163], v[92:95]
  v_mfma_f32_16x16x32_bf16 v[96:99], a[56:59], v[160:163], v[96:99]
  v_mfma_f32_16x16x32_bf16 v[100:103], a[60:63], v[160:163], v[100:103]
  buffer_load_dwordx4 v[160:163], v124, s[48:51], s71 offen offset:1024 sc1
  s_waitcnt lgkmcnt(0)
  s_waitcnt vmcnt(11)
  v_mfma_f32_16x16x32_bf16 v[8:11], a[64:67], v[164:167], v[8:11]
  s_add_u32 s72, s14, 3
  s_and_b32 s72, s72, 7
  v_mfma_f32_16x16x32_bf16 v[12:15], a[68:71], v[164:167], v[12:15]
  s_or_b32 s72, s72, 24
  s_mul_i32 s72, s72, 6144
  v_mfma_f32_16x16x32_bf16 v[16:19], a[72:75], v[164:167], v[16:19]
  s_add_u32 s72, s72, s8
  s_add_u32 s73, s72, 4096
  v_mfma_f32_16x16x32_bf16 v[20:23], a[76:79], v[164:167], v[20:23]
  v_add_u32 v4, s17, v134
  s_waitcnt vmcnt(10)
  v_mfma_f32_16x16x32_bf16 v[24:27], a[64:67], v[168:171], v[24:27]
  v_add_u32 v5, s17, v135
  v_add_u32 v6, s17, v136
  v_mfma_f32_16x16x32_bf16 v[28:31], a[68:71], v[168:171], v[28:31]
  v_add_u32 v7, s17, v137
  ds_read_b64_tr_b16 a[48:49], v4 offset:0
  v_mfma_f32_16x16x32_bf16 v[32:35], a[72:75], v[168:171], v[32:35]
  ds_read_b64_tr_b16 a[50:51], v4 offset:2048
  ds_read_b64_tr_b16 a[52:53], v5 offset:0
  v_mfma_f32_16x16x32_bf16 v[36:39], a[76:79], v[168:171], v[36:39]
  ds_read_b64_tr_b16 a[54:55], v5 offset:2048
  ds_read_b64_tr_b16 a[56:57], v6 offset:0
  s_waitcnt vmcnt(9)
  v_mfma_f32_16x16x32_bf16 v[40:43], a[64:67], v[172:175], v[40:43]
  ds_read_b64_tr_b16 a[58:59], v6 offset:2048
  ds_read_b64_tr_b16 a[60:61], v7 offset:0
  v_mfma_f32_16x16x32_bf16 v[44:47], a[68:71], v[172:175], v[44:47]
  ds_read_b64_tr_b16 a[62:63], v7 offset:2048
  buffer_load_dwordx4 v[164:167], v124, s[48:51], s72 offen offset:0 sc1
  v_mfma_f32_16x16x32_bf16 v[48:51], a[72:75], v[172:175], v[48:51]
  buffer_load_dwordx4 v[168:171], v124, s[48:51], s72 offen offset:1024 sc1
  v_mfma_f32_16x16x32_bf16 v[52:55], a[76:79], v[172:175], v[52:55]
  buffer_load_dwordx4 v[172:175], v124, s[48:51], s72 offen offset:2048 sc1
  s_waitcnt vmcnt(11)
  v_mfma_f32_16x16x32_bf16 v[56:59], a[64:67], v[176:179], v[56:59]
  v_mfma_f32_16x16x32_bf16 v[60:63], a[68:71], v[176:179], v[60:63]
  v_mfma_f32_16x16x32_bf16 v[64:67], a[72:75], v[176:179], v[64:67]
  v_mfma_f32_16x16x32_bf16 v[68:71], a[76:79], v[176:179], v[68:71]
  buffer_load_dwordx4 v[176:179], v124, s[48:51], s72 offen offset:3072 sc1
  s_waitcnt vmcnt(11)
  v_mfma_f32_16x16x32_bf16 v[72:75], a[64:67], v[180:183], v[72:75]
  v_mfma_f32_16x16x32_bf16 v[76:79], a[68:71], v[180:183], v[76:79]
  v_mfma_f32_16x16x32_bf16 v[80:83], a[72:75], v[180:183], v[80:83]
  v_mfma_f32_16x16x32_bf16 v[84:87], a[76:79], v[180:183], v[84:87]
  buffer_load_dwordx4 v[180:183], v124, s[48:51], s73 offen offset:0 sc1
  s_waitcnt vmcnt(11)
  v_mfma_f32_16x16x32_bf16 v[88:91], a[64:67], v[184:187], v[88:91]
  v_mfma_f32_16x16x32_bf16 v[92:95], a[68:71], v[184:187], v[92:95]
  v_mfma_f32_16x16x32_bf16 v[96:99], a[72:75], v[184:187], v[96:99]
  v_mfma_f32_16x16x32_bf16 v[100:103], a[76:79], v[184:187], v[100:103]
  buffer_load_dwordx4 v[184:187], v124, s[48:51], s73 offen offset:1024 sc1
  s_waitcnt lgkmcnt(0)
  s_waitcnt vmcnt(11)
  v_mfma_f32_16x16x32_bf16 v[8:11], a[48:51], v[140:143], v[8:11]
  s_add_u32 s70, s14, 4
  s_and_b32 s70, s70, 7
  v_mfma_f32_16x16x32_bf16 v[12:15], a[52:55], v[140:143], v[12:15]
  s_or_b32 s70, s70, 24
  s_mul_i32 s70, s70, 6144
  v_mfma_f32_16x16x32_bf16 v[16:19], a[56:59], v[140:143], v[16:19]
  s_add_u32 s70, s70, s8
  s_add_u32 s71, s70, 4096
  v_mfma_f32_16x16x32_bf16 v[20:23], a[60:63], v[140:143], v[20:23]
  v_add_u32 v4, s10, v134
  s_waitcnt vmcnt(10)
  v_mfma_f32_16x16x32_bf16 v[24:27], a[48:51], v[144:147], v[24:27]
  v_add_u32 v5, s10, v135
  v_add_u32 v6, s10, v136
  v_mfma_f32_16x16x32_bf16 v[28:31], a[52:55], v[144:147], v[28:31]
  v_add_u32 v7, s10, v137
  ds_read_b64_tr_b16 a[64:65], v4 offset:0
  v_mfma_f32_16x16x32_bf16 v[32:35], a[56:59], v[144:147], v[32:35]
  ds_read_b64_tr_b16 a[66:67], v4 offset:2048
  ds_read_b64_tr_b16 a[68:69], v5 offset:0
  v_mfma_f32_16x16x32_bf16 v[36:39], a[60:63], v[144:147], v[36:39]
  ds_read_b64_tr_b16 a[70:71], v5 offset:2048
  ds_read_b64_tr_b16 a[72:73], v6 offset:0
  s_waitcnt vmcnt(9)
  v_mfma_f32_16x16x32_bf16 v[40:43], a[48:51], v[148:151], v[40:43]
  ds_read_b64_tr_b16 a[74:75], v6 offset:2048
  ds_read_b64_tr_b16 a[76:77], v7 offset:0
  v_mfma_f32_16x16x32_bf16 v[44:47], a[52:55], v[148:151], v[44:47]
  ds_read_b64_tr_b16 a[78:79], v7 offset:2048
  buffer_load_dwordx4 v[140:143], v124, s[48:51], s70 offen offset:0 sc1
  v_mfma_f32_16x16x32_bf16 v[48:51], a[56:59], v[148:151], v[48:51]
  buffer_load_dwordx4 v[144:147], v124, s[48:51], s70 offen offset:1024 sc1
  v_mfma_f32_16x16x32_bf16 v[52:55], a[60:63], v[148:151], v[52:55]
  buffer_load_dwordx4 v[148:151], v124, s[48:51], s70 offen offset:2048 sc1
  s_waitcnt vmcnt(11)
  v_mfma_f32_16x16x32_bf16 v[56:59], a[48:51], v[152:155], v[56:59]
  v_mfma_f32_16x16x32_bf16 v[60:63], a[52:55], v[152:155], v[60:63]
  v_mfma_f32_16x16x32_bf16 v[64:67], a[56:59], v[152:155], v[64:67]
  v_mfma_f32_16x16x32_bf16 v[68:71], a[60:63], v[152:155], v[68:71]
  buffer_load_dwordx4 v[152:155], v124, s[48:51], s70 offen offset:3072 sc1
  s_waitcnt vmcnt(11)
  v_mfma_f32_16x16x32_bf16 v[72:75], a[48:51], v[156:159], v[72:75]
  v_mfma_f32_16x16x32_bf16 v[76:79], a[52:55], v[156:159], v[76:79]
  v_mfma_f32_16x16x32_bf16 v[80:83], a[56:59], v[156:159], v[80:83]
  v_mfma_f32_16x16x32_bf16 v[84:87], a[60:63], v[156:159], v[84:87]
  buffer_load_dwordx4 v[156:159], v124, s[48:51], s71 offen offset:0 sc1
  s_waitcnt vmcnt(11)
  v_mfma_f32_16x16x32_bf16 v[88:91], a[48:51], v[160:163], v[88:91]
  v_mfma_f32_16x16x32_bf16 v[92:95], a[52:55], v[160:163], v[92:95]
  v_mfma_f32_16x16x32_bf16 v[96:99], a[56:59], v[160:163], v[96:99]
  v_mfma_f32_16x16x32_bf16 v[100:103], a[60:63], v[160:163], v[100:103]
  buffer_load_dwordx4 v[160:163], v124, s[48:51], s71 offen offset:1024 sc1
  s_waitcnt lgkmcnt(0)
  s_waitcnt vmcnt(11)
  v_mfma_f32_16x16x32_bf16 v[8:11], a[64:67], v[164:167], v[8:11]
  s_add_u32 s72, s14, 5
  s_and_b32 s72, s72, 7
  v_mfma_f32_16x16x32_bf16 v[12:15], a[68:71], v[164:167], v[12:15]
  s_or_b32 s72, s72, 24
  s_mul_i32 s72, s72, 6144
  v_mfma_f32_16x16x32_bf16 v[16:19], a[72:75], v[164:167], v[16:19]
  s_add_u32 s72, s72, s8
  s_add_u32 s73, s72, 4096
  v_mfma_f32_16x16x32_bf16 v[20:23], a[76:79], v[164:167], v[20:23]
  v_add_u32 v4, s11, v134
  s_waitcnt vmcnt(10)
  v_mfma_f32_16x16x32_bf16 v[24:27], a[64:67], v[168:171], v[24:27]
  v_add_u32 v5, s11, v135
  v_add_u32 v6, s11, v136
  v_mfma_f32_16x16x32_bf16 v[28:31], a[68:71], v[168:171], v[28:31]
  v_add_u32 v7, s11, v137
  ds_read_b64_tr_b16 a[48:49], v4 offset:0
  v_mfma_f32_16x16x32_bf16 v[32:35], a[72:75], v[168:171], v[32:35]
  ds_read_b64_tr_b16 a[50:51], v4 offset:2048
  ds_read_b64_tr_b16 a[52:53], v5 offset:0
  v_mfma_f32_16x16x32_bf16 v[36:39], a[76:79], v[168:171], v[36:39]
  ds_read_b64_tr_b16 a[54:55], v5 offset:2048
  ds_read_b64_tr_b16 a[56:57], v6 offset:0
  s_waitcnt vmcnt(9)
  v_mfma_f32_16x16x32_bf16 v[40:43], a[64:67], v[172:175], v[40:43]
  ds_read_b64_tr_b16 a[58:59], v6 offset:2048
  ds_read_b64_tr_b16 a[60:61], v7 offset:0
  v_mfma_f32_16x16x32_bf16 v[44:47], a[68:71], v[172:175], v[44:47]
  ds_read_b64_tr_b16 a[62:63], v7 offset:2048
  buffer_load_dwordx4 v[164:167], v124, s[48:51], s72 offen offset:0 sc1
  v_mfma_f32_16x16x32_bf16 v[48:51], a[72:75], v[172:175], v[48:51]
  buffer_load_dwordx4 v[168:171], v124, s[48:51], s72 offen offset:1024 sc1
  v_mfma_f32_16x16x32_bf16 v[52:55], a[76:79], v[172:175], v[52:55]
  buffer_load_dwordx4 v[172:175], v124, s[48:51], s72 offen offset:2048 sc1
  s_waitcnt vmcnt(11)
  v_mfma_f32_16x16x32_bf16 v[56:59], a[64:67], v[176:179], v[56:59]
  v_mfma_f32_16x16x32_bf16 v[60:63], a[68:71], v[176:179], v[60:63]
  v_mfma_f32_16x16x32_bf16 v[64:67], a[72:75], v[176:179], v[64:67]
  v_mfma_f32_16x16x32_bf16 v[68:71], a[76:79], v[176:179], v[68:71]
  buffer_load_dwordx4 v[176:179], v124, s[48:51], s72 offen offset:3072 sc1
  s_waitcnt vmcnt(11)
  v_mfma_f32_16x16x32_bf16 v[72:75], a[64:67], v[180:183], v[72:75]
  v_mfma_f32_16x16x32_bf16 v[76:79], a[68:71], v[180:183], v[76:79]
  v_mfma_f32_16x16x32_bf16 v[80:83], a[72:75], v[180:183], v[80:83]
  v_mfma_f32_16x16x32_bf16 v[84:87], a[76:79], v[180:183], v[84:87]
  buffer_load_dwordx4 v[180:183], v124, s[48:51], s73 offen offset:0 sc1
  s_waitcnt vmcnt(11)
  v_mfma_f32_16x16x32_bf16 v[88:91], a[64:67], v[184:187], v[88:91]
  v_mfma_f32_16x16x32_bf16 v[92:95], a[68:71], v[184:187], v[92:95]
  v_mfma_f32_16x16x32_bf16 v[96:99], a[72:75], v[184:187], v[96:99]
  v_mfma_f32_16x16x32_bf16 v[100:103], a[76:79], v[184:187], v[100:103]
  buffer_load_dwordx4 v[184:187], v124, s[48:51], s73 offen offset:1024 sc1
  s_waitcnt lgkmcnt(0)
  s_waitcnt vmcnt(11)
  v_mfma_f32_16x16x32_bf16 v[8:11], a[48:51], v[140:143], v[8:11]
  s_add_u32 s70, s14, 6
  s_and_b32 s70, s70, 7
  v_mfma_f32_16x16x32_bf16 v[12:15], a[52:55], v[140:143], v[12:15]
  s_or_b32 s70, s70, 24
  s_mul_i32 s70, s70, 6144
  v_mfma_f32_16x16x32_bf16 v[16:19], a[56:59], v[140:143], v[16:19]
  s_add_u32 s70, s70, s8
  s_add_u32 s71, s70, 4096
  v_mfma_f32_16x16x32_bf16 v[20:23], a[60:63], v[140:143], v[20:23]
  v_add_u32 v4, s16, v134
  s_waitcnt vmcnt(10)
  v_mfma_f32_16x16x32_bf16 v[24:27], a[48:51], v[144:147], v[24:27]
  v_add_u32 v5, s16, v135
  v_add_u32 v6, s16, v136
  v_mfma_f32_16x16x32_bf16 v[28:31], a[52:55], v[144:147], v[28:31]
  v_add_u32 v7, s16, v137
  ds_read_b64_tr_b16 a[64:65], v4 offset:0
  v_mfma_f32_16x16x32_bf16 v[32:35], a[56:59], v[144:147], v[32:35]
  ds_read_b64_tr_b16 a[66:67], v4 offset:2048
  ds_read_b64_tr_b16 a[68:69], v5 offset:0
  v_mfma_f32_16x16x32_bf16 v[36:39], a[60:63], v[144:147], v[36:39]
  ds_read_b64_tr_b16 a[70:71], v5 offset:2048
  ds_read_b64_tr_b16 a[72:73], v6 offset:0
  s_waitcnt vmcnt(9)
  v_mfma_f32_16x16x32_bf16 v[40:43], a[48:51], v[148:151], v[40:43]
  ds_read_b64_tr_b16 a[74:75], v6 offset:2048
  ds_read_b64_tr_b16 a[76:77], v7 offset:0
  v_mfma_f32_16x16x32_bf16 v[44:47], a[52:55], v[148:151], v[44:47]
  ds_read_b64_tr_b16 a[78:79], v7 offset:2048
  buffer_load_dwordx4 v[140:143], v124, s[48:51], s70 offen offset:0 sc1
  v_mfma_f32_16x16x32_bf16 v[48:51], a[56:59], v[148:151], v[48:51]
  buffer_load_dwordx4 v[144:147], v124, s[48:51], s70 offen offset:1024 sc1
  v_mfma_f32_16x16x32_bf16 v[52:55], a[60:63], v[148:151], v[52:55]
  buffer_load_dwordx4 v[148:151], v124, s[48:51], s70 offen offset:2048 sc1
  s_waitcnt vmcnt(11)
  v_mfma_f32_16x16x32_bf16 v[56:59], a[48:51], v[152:155], v[56:59]
  v_mfma_f32_16x16x32_bf16 v[60:63], a[52:55], v[152:155], v[60:63]
  v_mfma_f32_16x16x32_bf16 v[64:67], a[56:59], v[152:155], v[64:67]
  v_mfma_f32_16x16x32_bf16 v[68:71], a[60:63], v[152:155], v[68:71]
  buffer_load_dwordx4 v[152:155], v124, s[48:51], s70 offen offset:3072 sc1
  s_waitcnt vmcnt(11)
  v_mfma_f32_16x16x32_bf16 v[72:75], a[48:51], v[156:159], v[72:75]
  v_mfma_f32_16x16x32_bf16 v[76:79], a[52:55], v[156:159], v[76:79]
  v_mfma_f32_16x16x32_bf16 v[80:83], a[56:59], v[156:159], v[80:83]
  v_mfma_f32_16x16x32_bf16 v[84:87], a[60:63], v[156:159], v[84:87]
  buffer_load_dwordx4 v[156:159], v124, s[48:51], s71 offen offset:0 sc1
  s_waitcnt vmcnt(11)
  v_mfma_f32_16x16x32_bf16 v[88:91], a[48:51], v[160:163], v[88:91]
  v_mfma_f32_16x16x32_bf16 v[92:95], a[52:55], v[160:163], v[92:95]
  v_mfma_f32_16x16x32_bf16 v[96:99], a[56:59], v[160:163], v[96:99]
  v_mfma_f32_16x16x32_bf16 v[100:103], a[60:63], v[160:163], v[100:103]
  buffer_load_dwordx4 v[160:163], v124, s[48:51], s71 offen offset:1024 sc1
  s_waitcnt lgkmcnt(0)
  s_waitcnt vmcnt(11)
  v_mfma_f32_16x16x32_bf16 v[8:11], a[64:67], v[164:167], v[8:11]
  s_add_u32 s72, s14, 7
  s_and_b32 s72, s72, 7
  v_mfma_f32_16x16x32_bf16 v[12:15], a[68:71], v[164:167], v[12:15]
  s_or_b32 s72, s72, 24
  s_mul_i32 s72, s72, 6144
  v_mfma_f32_16x16x32_bf16 v[16:19], a[72:75], v[164:167], v[16:19]
  s_add_u32 s72, s72, s8
  s_add_u32 s73, s72, 4096
  v_mfma_f32_16x16x32_bf16 v[20:23], a[76:79], v[164:167], v[20:23]
  v_add_u32 v4, s40, v134
  s_waitcnt vmcnt(10)
  v_mfma_f32_16x16x32_bf16 v[24:27], a[64:67], v[168:171], v[24:27]
  v_add_u32 v5, s40, v135
  v_add_u32 v6, s40, v136
  v_mfma_f32_16x16x32_bf16 v[28:31], a[68:71], v[168:171], v[28:31]
  v_add_u32 v7, s40, v137
  ds_read_b64_tr_b16 a[48:49], v4 offset:0
  v_mfma_f32_16x16x32_bf16 v[32:35], a[72:75], v[168:171], v[32:35]
  ds_read_b64_tr_b16 a[50:51], v4 offset:2048
  ds_read_b64_tr_b16 a[52:53], v5 offset:0
  v_mfma_f32_16x16x32_bf16 v[36:39], a[76:79], v[168:171], v[36:39]
  ds_read_b64_tr_b16 a[54:55], v5 offset:2048
  ds_read_b64_tr_b16 a[56:57], v6 offset:0
  s_waitcnt vmcnt(9)
  v_mfma_f32_16x16x32_bf16 v[40:43], a[64:67], v[172:175], v[40:43]
  ds_read_b64_tr_b16 a[58:59], v6 offset:2048
  ds_read_b64_tr_b16 a[60:61], v7 offset:0
  v_mfma_f32_16x16x32_bf16 v[44:47], a[68:71], v[172:175], v[44:47]
  ds_read_b64_tr_b16 a[62:63], v7 offset:2048
  buffer_load_dwordx4 v[164:167], v124, s[48:51], s72 offen offset:0 sc1
  v_mfma_f32_16x16x32_bf16 v[48:51], a[72:75], v[172:175], v[48:51]
  buffer_load_dwordx4 v[168:171], v124, s[48:51], s72 offen offset:1024 sc1
  v_mfma_f32_16x16x32_bf16 v[52:55], a[76:79], v[172:175], v[52:55]
  buffer_load_dwordx4 v[172:175], v124, s[48:51], s72 offen offset:2048 sc1
  s_waitcnt vmcnt(11)
  v_mfma_f32_16x16x32_bf16 v[56:59], a[64:67], v[176:179], v[56:59]
  v_mfma_f32_16x16x32_bf16 v[60:63], a[68:71], v[176:179], v[60:63]
  v_mfma_f32_16x16x32_bf16 v[64:67], a[72:75], v[176:179], v[64:67]
  v_mfma_f32_16x16x32_bf16 v[68:71], a[76:79], v[176:179], v[68:71]
  buffer_load_dwordx4 v[176:179], v124, s[48:51], s72 offen offset:3072 sc1
  s_waitcnt vmcnt(11)
  v_mfma_f32_16x16x32_bf16 v[72:75], a[64:67], v[180:183], v[72:75]
  v_mfma_f32_16x16x32_bf16 v[76:79], a[68:71], v[180:183], v[76:79]
  v_mfma_f32_16x16x32_bf16 v[80:83], a[72:75], v[180:183], v[80:83]
  v_mfma_f32_16x16x32_bf16 v[84:87], a[76:79], v[180:183], v[84:87]
  buffer_load_dwordx4 v[180:183], v124, s[48:51], s73 offen offset:0 sc1
  s_waitcnt vmcnt(11)
  v_mfma_f32_16x16x32_bf16 v[88:91], a[64:67], v[184:187], v[88:91]
  v_mfma_f32_16x16x32_bf16 v[92:95], a[68:71], v[184:187], v[92:95]
  v_mfma_f32_16x16x32_bf16 v[96:99], a[72:75], v[184:187], v[96:99]
  v_mfma_f32_16x16x32_bf16 v[100:103], a[76:79], v[184:187], v[100:103]
  buffer_load_dwordx4 v[184:187], v124, s[48:51], s73 offen offset:1024 sc1
  s_waitcnt lgkmcnt(0)
  s_waitcnt vmcnt(11)
  v_mfma_f32_16x16x32_bf16 v[8:11], a[48:51], v[140:143], v[8:11]
  v_mfma_f32_16x16x32_bf16 v[12:15], a[52:55], v[140:143], v[12:15]
  v_add_u32 v4, s41, v134
  v_mfma_f32_16x16x32_bf16 v[16:19], a[56:59], v[140:143], v[16:19]
  v_add_u32 v5, s41, v135
  v_add_u32 v6, s41, v136
  v_mfma_f32_16x16x32_bf16 v[20:23], a[60:63], v[140:143], v[20:23]
  v_add_u32 v7, s41, v137
  ds_read_b64_tr_b16 a[64:65], v4 offset:0
  s_waitcnt vmcnt(10)
  v_mfma_f32_16x16x32_bf16 v[24:27], a[48:51], v[144:147], v[24:27]
  ds_read_b64_tr_b16 a[66:67], v4 offset:2048
  ds_read_b64_tr_b16 a[68:69], v5 offset:0
  v_mfma_f32_16x16x32_bf16 v[28:31], a[52:55], v[144:147], v[28:31]
  ds_read_b64_tr_b16 a[70:71], v5 offset:2048
  ds_read_b64_tr_b16 a[72:73], v6 offset:0
  v_mfma_f32_16x16x32_bf16 v[32:35], a[56:59], v[144:147], v[32:35]
  ds_read_b64_tr_b16 a[74:75], v6 offset:2048
  ds_read_b64_tr_b16 a[76:77], v7 offset:0
  v_mfma_f32_16x16x32_bf16 v[36:39], a[60:63], v[144:147], v[36:39]
  ds_read_b64_tr_b16 a[78:79], v7 offset:2048
  s_waitcnt vmcnt(9)
  v_mfma_f32_16x16x32_bf16 v[40:43], a[48:51], v[148:151], v[40:43]
  v_mfma_f32_16x16x32_bf16 v[44:47], a[52:55], v[148:151], v[44:47]
  v_mfma_f32_16x16x32_bf16 v[48:51], a[56:59], v[148:151], v[48:51]
  v_mfma_f32_16x16x32_bf16 v[52:55], a[60:63], v[148:151], v[52:55]
  s_waitcnt vmcnt(8)
  v_mfma_f32_16x16x32_bf16 v[56:59], a[48:51], v[152:155], v[56:59]
  v_mfma_f32_16x16x32_bf16 v[60:63], a[52:55], v[152:155], v[60:63]
  v_mfma_f32_16x16x32_bf16 v[64:67], a[56:59], v[152:155], v[64:67]
  v_mfma_f32_16x16x32_bf16 v[68:71], a[60:63], v[152:155], v[68:71]
  s_waitcnt vmcnt(7)
  v_mfma_f32_16x16x32_bf16 v[72:75], a[48:51], v[156:159], v[72:75]
  v_mfma_f32_16x16x32_bf16 v[76:79], a[52:55], v[156:159], v[76:79]
  v_mfma_f32_16x16x32_bf16 v[80:83], a[56:59], v[156:159], v[80:83]
  v_mfma_f32_16x16x32_bf16 v[84:87], a[60:63], v[156:159], v[84:87]
  s_waitcnt vmcnt(6)
  v_mfma_f32_16x16x32_bf16 v[88:91], a[48:51], v[160:163], v[88:91]
  v_mfma_f32_16x16x32_bf16 v[92:95], a[52:55], v[160:163], v[92:95]
  v_mfma_f32_16x16x32_bf16 v[96:99], a[56:59], v[160:163], v[96:99]
  v_mfma_f32_16x16x32_bf16 v[100:103], a[60:63], v[160:163], v[100:103]
  s_waitcnt lgkmcnt(0)
  s_barrier
  s_waitcnt vmcnt(5)
  v_mfma_f32_16x16x32_bf16 v[8:11], a[64:67], v[164:167], v[8:11]
  v_mfma_f32_16x16x32_bf16 v[12:15], a[68:71], v[164:167], v[12:15]
  v_mfma_f32_16x16x32_bf16 v[16:19], a[72:75], v[164:167], v[16:19]
  v_mfma_f32_16x16x32_bf16 v[20:23], a[76:79], v[164:167], v[20:23]
  s_waitcnt vmcnt(4)
  v_mfma_f32_16x16x32_bf16 v[24:27], a[64:67], v[168:171], v[24:27]
  v_mfma_f32_16x16x32_bf16 v[28:31], a[68:71], v[168:171], v[28:31]
  s_nop 1
  ds_write_b128 v104, v[8:11] offset:0
  v_mfma_f32_16x16x32_bf16 v[32:35], a[72:75], v[168:171], v[32:35]
  ds_write_b128 v104, v[12:15] offset:64
  v_mfma_f32_16x16x32_bf16 v[36:39], a[76:79], v[168:171], v[36:39]
  ds_write_b128 v104, v[16:19] offset:128
  s_waitcnt vmcnt(3)
  v_mfma_f32_16x16x32_bf16 v[40:43], a[64:67], v[172:175], v[40:43]
  ds_write_b128 v104, v[20:23] offset:192
  v_mfma_f32_16x16x32_bf16 v[44:47], a[68:71], v[172:175], v[44:47]
  ds_write_b128 v104, v[24:27] offset:4352
  v_mfma_f32_16x16x32_bf16 v[48:51], a[72:75], v[172:175], v[48:51]
  ds_write_b128 v104, v[28:31] offset:4416
  v_mfma_f32_16x16x32_bf16 v[52:55], a[76:79], v[172:175], v[52:55]
  ds_write_b128 v104, v[32:35] offset:4480
  s_waitcnt vmcnt(2)
  v_mfma_f32_16x16x32_bf16 v[56:59], a[64:67], v[176:179], v[56:59]
  ds_write_b128 v104, v[36:39] offset:4544
  v_mfma_f32_16x16x32_bf16 v[60:63], a[68:71], v[176:179], v[60:63]
  ds_write_b128 v104, v[40:43] offset:8704
  v_mfma_f32_16x16x32_bf16 v[64:67], a[72:75], v[176:179], v[64:67]
  ds_write_b128 v104, v[44:47] offset:8768
  v_mfma_f32_16x16x32_bf16 v[68:71], a[76:79], v[176:179], v[68:71]
  ds_write_b128 v104, v[48:51] offset:8832
  s_waitcnt vmcnt(1)
  v_mfma_f32_16x16x32_bf16 v[72:75], a[64:67], v[180:183], v[72:75]
  ds_write_b128 v104, v[52:55] offset:8896
  v_mfma_f32_16x16x32_bf16 v[76:79], a[68:71], v[180:183], v[76:79]
  ds_write_b128 v104, v[56:59] offset:13056
  v_mfma_f32_16x16x32_bf16 v[80:83], a[72:75], v[180:183], v[80:83]
  ds_write_b128 v104, v[60:63] offset:13120
  v_mfma_f32_16x16x32_bf16 v[84:87], a[76:79], v[180:183], v[84:87]
  ds_write_b128 v104, v[64:67] offset:13184
  s_waitcnt vmcnt(0)
  v_mfma_f32_16x16x32_bf16 v[88:91], a[64:67], v[184:187], v[88:91]
  ds_write_b128 v104, v[68:71] offset:13248
  v_mfma_f32_16x16x32_bf16 v[92:95], a[68:71], v[184:187], v[92:95]
  ds_write_b128 v104, v[72:75] offset:17408
  v_mfma_f32_16x16x32_bf16 v[96:99], a[72:75], v[184:187], v[96:99]
  ds_write_b128 v104, v[76:79] offset:17472
  v_mfma_f32_16x16x32_bf16 v[100:103], a[76:79], v[184:187], v[100:103]
  ds_write_b128 v104, v[80:83] offset:17536
  ds_write_b128 v104, v[84:87] offset:17600
  ds_write_b128 v104, v[88:91] offset:21760
  s_nop 0
  ds_write_b128 v104, v[92:95] offset:21824
  s_nop 0
  ds_write_b128 v104, v[96:99] offset:21888
  s_nop 0
  ds_write_b128 v104, v[100:103] offset:21952
  s_waitcnt lgkmcnt(0)
  s_barrier
  ds_read_b128 v[132:135], v105 offset:0
  ds_read_b128 v[136:139], v105 offset:16
  ds_read_b128 v[140:143], v105 offset:26112
  ds_read_b128 v[144:147], v105 offset:26128
  ds_read_b128 v[148:151], v106 offset:0
  ds_read_b128 v[152:155], v106 offset:16
  ds_read_b128 v[156:159], v106 offset:26112
  ds_read_b128 v[160:163], v106 offset:26128
  ds_read_b128 v[164:167], v105 offset:2176
  ds_read_b128 v[168:171], v105 offset:2192
  ds_read_b128 v[172:175], v105 offset:28288
  ds_read_b128 v[176:179], v105 offset:28304
  ds_read_b128 v[180:183], v106 offset:2176
  ds_read_b128 v[184:187], v106 offset:2192
  ds_read_b128 v[188:191], v106 offset:28288
  ds_read_b128 v[192:195], v106 offset:28304
  ds_read_b128 v[196:199], v105 offset:4352
  ds_read_b128 v[200:203], v105 offset:4368
  ds_read_b128 v[204:207], v105 offset:30464
  ds_read_b128 v[208:211], v105 offset:30480
  ds_read_b128 v[212:215], v106 offset:4352
  ds_read_b128 v[216:219], v106 offset:4368
  ds_read_b128 v[220:223], v106 offset:30464
  ds_read_b128 v[224:227], v106 offset:30480
  s_waitcnt lgkmcnt(15)
  v_add_f32 v132, v132, v140
  v_add_f32 v148, v148, v156
  v_add_f32 v133, v133, v141
  v_add_f32 v149, v149, v157
  v_add_f32 v134, v134, v142
  v_add_f32 v150, v150, v158
  v_add_f32 v135, v135, v143
  v_add_f32 v151, v151, v159
  v_add_f32 v136, v136, v144
  v_add_f32 v152, v152, v160
  v_add_f32 v137, v137, v145
  v_add_f32 v153, v153, v161
  v_add_f32 v138, v138, v146
  v_add_f32 v154, v154, v162
  v_add_f32 v139, v139, v147
  v_add_f32 v155, v155, v163
  v_add_f32 v132, v132, v148
  v_add_f32 v133, v133, v149
  v_add_f32 v134, v134, v150
  v_add_f32 v135, v135, v151
  v_add_f32 v136, v136, v152
  v_add_f32 v137, v137, v153
  v_add_f32 v138, v138, v154
  v_add_f32 v139, v139, v155
  v_cvt_pk_bf16_f32 v132, v132, v133
  v_cvt_pk_bf16_f32 v133, v134, v135
  v_cvt_pk_bf16_f32 v134, v136, v137
  v_cvt_pk_bf16_f32 v135, v138, v139
  s_add_u32 s4, s78, 0
  buffer_store_dwordx4 v[132:135], v107, s[56:59], s4 offen sc1
  s_waitcnt lgkmcnt(13)
  v_add_f32 v164, v164, v172
  s_waitcnt lgkmcnt(9)
  v_add_f32 v180, v180, v188
  v_add_f32 v165, v165, v173
  v_add_f32 v181, v181, v189
  v_add_f32 v166, v166, v174
  v_add_f32 v182, v182, v190
  v_add_f32 v167, v167, v175
  v_add_f32 v183, v183, v191
  v_add_f32 v168, v168, v176
  s_waitcnt lgkmcnt(8)
  v_add_f32 v184, v184, v192
  v_add_f32 v169, v169, v177
  v_add_f32 v185, v185, v193
  v_add_f32 v170, v170, v178
  v_add_f32 v186, v186, v194
  v_add_f32 v171, v171, v179
  v_add_f32 v187, v187, v195
  v_add_f32 v164, v164, v180
  v_add_f32 v165, v165, v181
  v_add_f32 v166, v166, v182
  v_add_f32 v167, v167, v183
  v_add_f32 v168, v168, v184
  v_add_f32 v169, v169, v185
  v_add_f32 v170, v170, v186
  v_add_f32 v171, v171, v187
  v_cvt_pk_bf16_f32 v164, v164, v165
  v_cvt_pk_bf16_f32 v165, v166, v167
  v_cvt_pk_bf16_f32 v166, v168, v169
  v_cvt_pk_bf16_f32 v167, v170, v171
  s_add_u32 s4, s78, 32768
  buffer_store_dwordx4 v[164:167], v107, s[56:59], s4 offen sc1
  s_waitcnt lgkmcnt(5)
  v_add_f32 v196, v196, v204
  s_waitcnt lgkmcnt(1)
  v_add_f32 v212, v212, v220
  v_add_f32 v197, v197, v205
  v_add_f32 v213, v213, v221
  v_add_f32 v198, v198, v206
  v_add_f32 v214, v214, v222
  v_add_f32 v199, v199, v207
  v_add_f32 v215, v215, v223
  v_add_f32 v200, v200, v208
  s_waitcnt lgkmcnt(0)
  v_add_f32 v216, v216, v224
  v_add_f32 v201, v201, v209
  v_add_f32 v217, v217, v225
  v_add_f32 v202, v202, v210
  v_add_f32 v218, v218, v226
  v_add_f32 v203, v203, v211
  v_add_f32 v219, v219, v227
  v_add_f32 v196, v196, v212
  v_add_f32 v197, v197, v213
  v_add_f32 v198, v198, v214
  v_add_f32 v199, v199, v215
  v_add_f32 v200, v200, v216
  v_add_f32 v201, v201, v217
  v_add_f32 v202, v202, v218
  v_add_f32 v203, v203, v219
  v_cvt_pk_bf16_f32 v196, v196, v197
  v_cvt_pk_bf16_f32 v197, v198, v199
  v_cvt_pk_bf16_f32 v198, v200, v201
  v_cvt_pk_bf16_f32 v199, v202, v203
  s_add_u32 s4, s78, 65536
  buffer_store_dwordx4 v[196:199], v107, s[56:59], s4 offen sc1
  s_waitcnt vmcnt(0)
L_exit_ached__near_ridge_kernel:
  s_endpgm
.section .rodata,"a"
.p2align 6
.amdhsa_kernel concat_heads__mha_block_cached__gqa_block_cached__near_ridge_kernel
  .amdhsa_next_free_vgpr 512
  .amdhsa_next_free_sgpr 102
  .amdhsa_accum_offset 256
  .amdhsa_group_segment_fixed_size 0
  .amdhsa_kernarg_size 104
  .amdhsa_user_sgpr_count 2
  .amdhsa_user_sgpr_kernarg_segment_ptr 1
  .amdhsa_system_sgpr_workgroup_id_x 1
.end_amdhsa_kernel
.text
```
